```python
import torch

def _softmax(x, axis=-1):
    return torch.softmax(x, dim=axis)
def _gelu(x):
    return torch.nn.functional.gelu(x, approximate="tanh")
def _silu(x):
    return torch.nn.functional.silu(x)
def _sigmoid(x):
    return torch.sigmoid(x)
def _layernorm(x, axis=-1, eps=1e-5):
    m = x.mean(dim=axis, keepdim=True)
    v = x.var(dim=axis, keepdim=True, unbiased=False)
    return (x - m) / torch.sqrt(v + eps)
def _scatter_add(tgt, idx, src, axis=0):
    return tgt.clone().index_add_(axis, idx, src)
def _segment_sum(src, seg, n):
    out = torch.zeros((n,) + src.shape[1:], dtype=src.dtype)
    return out.index_add_(0, seg, src)
def _pad(x, pw):
    flat = tuple(v for pair in reversed(pw) for v in pair)
    return torch.nn.functional.pad(x, flat)

kernel_name = 'recurrent_scan__linear_kernel_hedgehog__glu_gated_geglu__prompt'

def setup_inputs():

    _w = (lambda a: (lambda t: t.to(torch.bfloat16) if t.is_floating_point() else t)(torch.as_tensor(a)))
    def _A_setup():
        B, S, D, H = 1, 2048, 448, 16
        Dh = D // H
        return {
            "x": _w((lambda *s: torch.randn(*s, dtype=torch.bfloat16) * 0.05)(B, S, D)),
            "wqkv": _w((lambda *s: torch.randn(*s, dtype=torch.bfloat16) * 0.8)(D, 3 * D)),
            "w_phi": _w((lambda *s: torch.randn(*s, dtype=torch.bfloat16) * 0.8)(H, Dh, Dh) * (Dh ** -0.5)),
            "wo": _w((lambda *s: torch.randn(*s, dtype=torch.bfloat16) * 0.8)(D, D)),
        }
    _A_in = _A_setup()

    def _B_setup():
        B, S, Dm, Df = 1, 2048, 448, 1792
        return {
            "x": _w((lambda *s: torch.randn(*s, dtype=torch.bfloat16) * 0.05)(B, S, Dm)),
            "w_gate": _w((lambda *s: torch.randn(*s, dtype=torch.bfloat16) * 0.2)(Dm, Df) * (Dm ** -0.5)),
            "w_up": _w((lambda *s: torch.randn(*s, dtype=torch.bfloat16) * 0.2)(Dm, Df) * (Dm ** -0.5)),
            "w_down": _w((lambda *s: torch.randn(*s, dtype=torch.bfloat16) * 0.2)(Df, Dm) * (Df ** -0.5)),
        }
    _B_in = _B_setup()

    return {
        "A_x": _A_in["x"],
        "A_wqkv": _A_in["wqkv"],
        "A_w_phi": _A_in["w_phi"],
        "A_wo": _A_in["wo"],
        "B_x": _B_in["x"],
        "B_w_gate": _B_in["w_gate"],
        "B_w_up": _B_in["w_up"],
        "B_w_down": _B_in["w_down"],
    }

def reference(A_x, A_wqkv, A_w_phi, A_wo, B_x, B_w_gate, B_w_up, B_w_down):
    def _A_ref(x, wqkv, w_phi, wo):
        B, S, D = x.shape
        H = 16; Dh = D // H
        qkv = (lambda x, *d: x.permute(*d))((x @ wqkv).reshape(B, S, 3, H, Dh), 2, 0, 3, 1, 4)
        q, k, v = qkv[0], qkv[1], qkv[2]
        pq = torch.einsum("bhsd,hdf->bhsf", q, w_phi)
        pk = torch.einsum("bhsd,hdf->bhsf", k, w_phi)
        phi_q = torch.concatenate([_softmax(pq, axis=-1), _softmax(-pq, axis=-1)], axis=-1)
        phi_k = torch.concatenate([_softmax(pk, axis=-1), _softmax(-pk, axis=-1)], axis=-1)
        kv = torch.einsum("bhsf,bhsd->bhfd", phi_k, v)
        z  = torch.einsum("bhsf->bhf", phi_k)
        num = torch.einsum("bhqf,bhfd->bhqd", phi_q, kv)
        den = torch.einsum("bhqf,bhf->bhq", phi_q, z)[..., None] + 1e-6
        o = num / den
        return (lambda x, *d: x.permute(*d))(o, 0, 2, 1, 3).reshape(B, S, D) @ wo

    def _B_ref(x, w_gate, w_up, w_down):
        g = torch.einsum("bsd,df->bsf", x, w_gate)
        u = torch.einsum("bsd,df->bsf", x, w_up)
        h = _gelu(g) * u
        return torch.einsum("bsf,fd->bsd", h, w_down)

    x = A_x
    xn = _layernorm(x, axis=-1)
    s = _A_ref(xn, A_wqkv, A_w_phi, A_wo)
    g = _silu(_B_ref(xn, B_w_gate, B_w_up, B_w_down))
    return x + s * g
```

```asm
; @launch grid=(256,1,1) block=(512,1,1) lds=163840
.amdgcn_target "amdgcn-amd-amdhsa--gfx950"
.text
.globl recurrent_scan__linear_kernel_hedgehog__glu_gated_geglu__prompt_kernel
.p2align 8
.type recurrent_scan__linear_kernel_hedgehog__glu_gated_geglu__prompt_kernel,@function
recurrent_scan__linear_kernel_hedgehog__glu_gated_geglu__prompt_kernel:
    s_cmp_ge_u32 s2, 256
    s_cbranch_scc1 KM_EXIT
    s_load_dwordx16 s[4:19], s[0:1], 0
    s_load_dwordx4 s[20:23], s[0:1], 64
    s_load_dwordx2 s[24:25], s[0:1], 80
    s_bfe_u32 s26, s2, 0x20005
    s_lshr_b32 s27, s2, 7
    s_lshl_b32 s26, s26, 1
    s_or_b32 s26, s26, s27
    s_lshl_b32 s26, s26, 5
    s_and_b32 s2, s2, 31
    s_or_b32 s2, s2, s26
    s_getpc_b64 s[56:57]
KM_PC:
    s_lshr_b32 s26, s2, 3
    s_mul_i32 s26, s26, 1408
    v_min_u32 v34, 11, v0
    v_lshlrev_b32 v34, 7, v34
    v_add_u32 v34, s26, v34
    v_min_u32 v34, KM_EXIT-KM_PC, v34
    v_mov_b32 v35, s57
    v_add_co_u32 v34, vcc, s56, v34
    s_nop 1
    v_addc_co_u32 v35, vcc, 0, v35, vcc
    global_load_dword v249, v[34:35], off
    v_lshrrev_b32 v26, 6, v0
    v_and_b32 v27, 63, v0
    v_readfirstlane_b32 s68, v26
    s_bfe_u32 s74, s2, 0x20001
    s_lshr_b32 s73, s2, 6
    s_lshl_b32 s71, s74, 2
    s_add_u32 s71, s71, s73
    s_bfe_u32 s73, s2, 0x10003
    s_mul_i32 s73, s73, 3
    s_add_u32 s74, s74, s73
    s_lshl_b32 s76, s74, 7
    s_lshr_b32 s73, s2, 2
    s_andn2_b32 s73, s73, 1
    s_add_u32 s73, s73, s68
    s_and_b32 s73, s73, 15
    s_lshl_b32 s73, s73, 3
    v_lshrrev_b32 v30, 3, v27
    v_and_b32 v31, 7, v27
    v_add_u32 v32, s73, v30
    v_mul_u32_u24 v28, 896, v32
    v_lshl_add_u32 v28, v31, 4, v28
    s_lshr_b32 s70, s68, 2
    s_mul_i32 s75, s71, 114688
    s_add_u32 s77, s76, 128
    s_cmp_eq_u32 s77, 896
    s_cselect_b32 s77, 0, s77
    s_add_u32 s78, s77, 128
    s_cmp_eq_u32 s78, 896
    s_cselect_b32 s78, 0, s78
    s_add_u32 s79, s78, 128
    s_cmp_eq_u32 s79, 896
    s_cselect_b32 s79, 0, s79
    s_waitcnt lgkmcnt(0)
    s_add_u32 s28, s4, s75
    s_addc_u32 s29, s5, 0
    s_sub_u32 s30, 1835008, s75
    s_mov_b32 s31, 0x20000
    s_cmp_lg_u32 s70, 0
    s_cbranch_scc1 KM_T
    buffer_load_dwordx4 v[80:83], v28, s[28:31], s76 offen
    buffer_load_dwordx4 v[84:87], v28, s[28:31], s77 offen
    buffer_load_dwordx4 v[88:91], v28, s[28:31], s78 offen
    buffer_load_dwordx4 v[92:95], v28, s[28:31], s79 offen
KM_T:
    s_add_u32 s80, s79, 128
    s_cmp_eq_u32 s80, 896
    s_cselect_b32 s80, 0, s80
    s_add_u32 s81, s80, 128
    s_cmp_eq_u32 s81, 896
    s_cselect_b32 s81, 0, s81
    s_add_u32 s82, s81, 128
    s_cmp_eq_u32 s82, 896
    s_cselect_b32 s82, 0, s82
    s_lshl_b32 s75, s68, 10
    s_and_b32 s72, s2, 1
    s_lshl_b32 s72, s72, 2
    s_bfe_u32 s73, s2, 0x20003
    s_add_u32 s72, s72, s73
    s_mul_i32 s97, s72, 192
    s_add_u32 s97, s97, 256
    s_lshl_b32 s27, s97, 1
    s_mul_i32 s98, s72, 112
    s_add_u32 s26, s98, 896
    s_movk_i32 s89, 3584
    s_bitcmp1_b32 s2, 5
    s_cselect_b32 s27, s26, s27
    s_cselect_b32 s89, 2688, s89
    s_cselect_b32 s88, 6, 7
    s_cselect_b64 s[52:53], s[6:7], s[14:15]
    v_lshrrev_b32 v34, 3, v0
    v_bfe_u32 v35, v27, 4, 1
    v_lshlrev_b32 v35, 2, v35
    v_xor_b32 v35, v35, v31
    v_xor_b32 v36, 2, v35
    v_mul_u32_u24 v34, s89, v34
    v_min_u32 v35, s88, v35
    v_lshl_add_u32 v2, v35, 4, v34
    v_lshl_add_u32 v3, v36, 4, v34
    v_mov_b32 v4, v2
    s_lshr_b32 s88, s89, 1
    s_mul_i32 s83, s76, s88
    s_lshl_b32 s84, s89, 5
    s_add_u32 s84, s84, s83
    s_mul_i32 s89, s89, 448
    s_add_u32 s32, s52, s27
    s_addc_u32 s33, s53, 0
    s_sub_u32 s34, s89, s27
    s_mov_b32 s35, 0x20000
    s_add_u32 s36, s16, s27
    s_addc_u32 s37, s17, 0
    s_sub_u32 s38, 1605632, s27
    s_mov_b32 s39, 0x20000
    s_cmp_lg_u32 s70, 0
    s_cbranch_scc1 KM_Y
    s_add_u32 m0, s75, 114688
    s_nop 0
    buffer_load_dwordx4 v2, s[32:35], s83 offen lds
    s_add_u32 m0, s75, 118784
    s_nop 0
    buffer_load_dwordx4 v2, s[32:35], s84 offen lds
    s_bitcmp1_b32 s2, 5
    s_cbranch_scc1 KM_A
    s_add_u32 m0, s75, 122880
    s_nop 0
    buffer_load_dwordx4 v3, s[36:39], s83 offen lds
    s_add_u32 m0, s75, 126976
    s_nop 0
    buffer_load_dwordx4 v3, s[36:39], s84 offen lds
KM_A:
    buffer_load_dwordx4 v[96:99], v28, s[28:31], s80 offen
    buffer_load_dwordx4 v[100:103], v28, s[28:31], s81 offen
    buffer_load_dwordx4 v[104:107], v28, s[28:31], s82 offen
KM_Y:
    v_mov_b32 v56, 0x3f803f80
    v_mov_b32 v57, 0x3f803f80
    v_and_b32 v34, 1, v27
    v_lshlrev_b32 v35, 4, v34
    v_mov_b32 v36, 0x3f80
    v_lshlrev_b32 v36, v35, v36
    v_and_b32 v35, 2, v27
    v_cmp_eq_u32 s[62:63], 0, v35
    v_cmp_eq_u32 s[60:61], 0, v34
    s_nop 0
    v_cndmask_b32 v58, 0, v36, s[62:63]
    v_cndmask_b32 v59, v36, 0, s[62:63]
    v_bfe_u32 v36, v32, 1, 3
    v_xor_b32 v36, v36, v31
    v_lshlrev_b32 v36, 4, v36
    v_lshl_add_u32 v40, v32, 7, v36
    v_add_u32 v41, 0x10000, v40
    v_xor_b32 v42, 0x2000, v40
    v_xor_b32 v43, 0x2000, v41
    v_xor_b32 v33, 64, v32
    v_mul_u32_u24 v29, 896, v33
    v_lshl_add_u32 v29, v31, 4, v29
    v_lshlrev_b32 v1, 4, v27
    s_and_b32 s69, s68, 3
    s_bitcmp1_b32 s2, 5
    s_cbranch_scc0 KM_SF
KM_SH:
    v_lshrrev_b32 v34, 5, v27
    v_bfe_u32 v35, v27, 2, 2
    v_lshl_add_u32 v34, v34, 3, v35
    v_and_b32 v35, 3, v27
    v_lshlrev_b32 v35, 3, v35
    v_bfe_u32 v36, v27, 4, 1
    v_bfe_u32 v37, v27, 3, 1
    v_lshlrev_b32 v37, 6, v37
    v_lshl_add_u32 v35, v36, 5, v35
    s_mul_i32 s26, s70, 56
    v_add_u32 v35, s26, v35
    v_xor_b32 v35, v35, v37
    v_lshl_add_u32 v7, v34, 7, v35
    v_and_b32 v34, 31, v27
    s_lshl_b32 s26, s69, 5
    v_add_u32 v34, s26, v34
    v_bfe_u32 v35, v27, 1, 3
    v_lshrrev_b32 v36, 5, v27
    v_xor_b32 v35, v35, v36
    v_lshlrev_b32 v35, 4, v35
    v_lshl_add_u32 v11, v34, 7, v35
    v_xor_b32 v12, 32, v11
    v_xor_b32 v13, 64, v11
    v_xor_b32 v14, 96, v11
    s_add_u32 s27, s98, 1792
    s_add_u32 s40, s6, s27
    s_addc_u32 s41, s7, 0
    s_sub_u32 s42, 1204224, s27
    s_mov_b32 s43, 0x20000
    s_add_u32 s44, s6, s98
    s_addc_u32 s45, s7, 0
    s_sub_u32 s46, 1204224, s98
    s_mov_b32 s47, 0x20000
    s_mov_b32 s100, 0
    s_mov_b32 s101, -1
    v_lshrrev_b32 v34, 5, v27
    v_bfe_u32 v35, v27, 2, 2
    v_lshl_add_u32 v34, v34, 2, v35
    v_mul_u32_u24 v34, 56, v34
    v_bfe_u32 v35, v27, 4, 1
    v_and_b32 v36, 3, v27
    v_lshl_add_u32 v35, v35, 2, v36
    v_lshl_add_u32 v34, v35, 3, v34
    v_add_u32 v35, 1, v35
    v_lshrrev_b32 v35, 3, v35
    v_mul_u32_u24 v35, 4608, v35
    s_mul_i32 s26, s70, 1568
    s_add_u32 s26, s26, 155648
    v_add3_u32 v47, v34, v35, s26
    s_lshl_b32 s99, s72, 5
    s_lshl_b32 s27, s72, 6
    s_cmp_eq_u32 s70, 0
    s_cselect_b64 s[52:53], s[14:15], s[16:17]
    s_add_u32 s48, s52, s27
    s_addc_u32 s49, s53, 0
    s_sub_u32 s50, 1605632, s27
    s_mov_b32 s51, 0x20000
    v_bfe_u32 v34, v0, 2, 6
    v_mul_u32_u24 v34, 3584, v34
    s_lshl_b32 s26, s70, 1
    v_and_b32 v35, 3, v27
    v_xor_b32 v35, s26, v35
    v_lshl_add_u32 v2, v35, 4, v34
    v_lshrrev_b32 v34, 5, v27
    v_bfe_u32 v35, v27, 2, 2
    v_lshl_add_u32 v34, v34, 3, v35
    v_and_b32 v35, 3, v27
    v_lshlrev_b32 v35, 3, v35
    v_bfe_u32 v36, v27, 4, 1
    v_xor_b32 v37, s70, v36
    v_lshl_add_u32 v35, v37, 5, v35
    v_lshl_add_u32 v35, v36, 12, v35
    v_lshl_add_u32 v6, v34, 6, v35
    s_mov_b32 s56, s24
    s_mov_b32 s57, s25
    s_mov_b32 s58, 12664832
    s_mov_b32 s59, 0x20000
    s_lshl_b32 s26, s71, 2
    s_add_u32 s26, s26, s69
    s_mul_i32 s27, s26, 147456
    s_lshl_b32 s99, s99, 6
    s_add_u32 s99, s99, s27
    s_lshl_b32 s73, s70, 10
    s_add_u32 s99, s99, s73
    s_lshl_b32 s74, s72, 1
    s_add_u32 s74, s74, s70
    s_lshl_b32 s90, s74, 11
    s_add_u32 s90, s90, s27
    s_add_u32 s90, s90, 114688
    s_lshl_b32 s92, s74, 2
    s_add_u32 s92, s92, s69
    s_lshl_b32 s92, s92, 15
    s_add_u32 s92, s92, 10485760
    s_lshl_b32 s26, s71, 11
    s_add_u32 s91, s92, s26
    s_lshl_b32 s26, s71, 7
    s_add_u32 s92, s92, s26
    s_lshl_b32 s96, s74, 12
    s_add_u32 s96, s96, 12582912
    s_and_b32 s93, s69, 1
    s_lshl_b32 s93, s93, 1
    s_lshr_b32 s26, s71, 3
    s_add_u32 s93, s93, s26
    s_lshl_b32 s93, s93, 10
    s_lshr_b32 s26, s69, 1
    s_lshl_b32 s26, s26, 8
    s_add_u32 s93, s93, s26
    s_and_b32 s26, s71, 1
    s_lshl_b32 s26, s26, 7
    s_add_u32 s93, s93, s26
    s_bfe_u32 s26, s71, 0x10001
    s_lshl_b32 s26, s26, 9
    s_add_u32 s93, s93, s26
    s_bfe_u32 s26, s71, 0x10002
    s_lshl_b32 s26, s26, 3
    s_add_u32 s93, s93, s26
    s_add_u32 s93, s93, s96
    s_mul_i32 s26, s70, 29696
    s_add_u32 s26, s26, 49152
    s_lshl_b32 s27, s69, 5
    v_and_b32 v34, 31, v27
    v_add_u32 v34, s27, v34
    v_mul_u32_u24 v34, 232, v34
    v_lshrrev_b32 v35, 5, v27
    v_lshl_add_u32 v34, v35, 3, v34
    v_add_u32 v15, s26, v34
    v_bfe_u32 v34, v27, 2, 3
    v_lshlrev_b32 v34, 2, v34
    v_lshl_add_u32 v34, v35, 1, v34
    v_mul_u32_u24 v34, 232, v34
    v_and_b32 v35, 3, v27
    v_lshl_add_u32 v34, v35, 3, v34
    v_add_u32 v34, s26, v34
    s_and_b32 s26, s69, 1
    s_lshl_b32 s26, s26, 6
    v_add_u32 v16, s26, v34
    s_lshr_b32 s26, s69, 1
    s_lshl_b32 s26, s26, 5
    s_add_u32 s26, s26, 128
    v_add_u32 v17, s26, v34
    v_mov_b32 v48, -1
    v_mov_b32 v49, -1
    v_mov_b32 v50, -1
    v_mov_b32 v51, -1
    v_and_b32 v34, 7, v0
    v_bfe_u32 v52, v0, 5, 1
    v_lshlrev_b32 v52, 2, v52
    v_lshl_add_u32 v52, v34, 4, v52
    v_and_b32 v35, 24, v0
    v_lshlrev_b32 v35, 26, v35
    v_or_b32 v52, v52, v35
    s_cmp_lg_u32 s70, 0
    s_cbranch_scc1 KM_X0
    s_branch KM_X1
KM_SF:
    v_lshrrev_b32 v34, 5, v27
    v_bfe_u32 v35, v27, 2, 2
    v_lshl_add_u32 v34, v34, 3, v35
    v_and_b32 v35, 3, v27
    v_lshlrev_b32 v35, 3, v35
    v_bfe_u32 v36, v27, 4, 1
    v_bfe_u32 v37, v27, 3, 1
    v_lshlrev_b32 v37, 6, v37
    v_lshl_add_u32 v35, v36, 5, v35
    s_mul_i32 s26, s70, 64
    v_add_u32 v35, s26, v35
    v_xor_b32 v35, v35, v37
    v_lshl_add_u32 v6, v34, 7, v35
    v_and_b32 v34, 31, v27
    s_lshl_b32 s26, s69, 5
    v_add_u32 v34, s26, v34
    v_bfe_u32 v35, v27, 1, 3
    v_lshrrev_b32 v36, 5, v27
    v_xor_b32 v35, v35, v36
    v_lshlrev_b32 v35, 4, v35
    v_lshl_add_u32 v11, v34, 7, v35
    v_xor_b32 v12, 32, v11
    v_xor_b32 v13, 64, v11
    v_xor_b32 v14, 96, v11
    s_add_u32 s98, s97, 64
    s_lshl_b32 s27, s98, 1
    s_add_u32 s40, s14, s27
    s_addc_u32 s41, s15, 0
    s_sub_u32 s42, 1605632, s27
    s_mov_b32 s43, 0x20000
    s_add_u32 s44, s16, s27
    s_addc_u32 s45, s17, 0
    s_sub_u32 s46, 1605632, s27
    s_mov_b32 s47, 0x20000
    s_add_u32 s99, s97, 128
    s_lshl_b32 s27, s99, 1
    s_add_u32 s48, s14, s27
    s_addc_u32 s49, s15, 0
    s_sub_u32 s50, 1605632, s27
    s_mov_b32 s51, 0x20000
    s_add_u32 s52, s16, s27
    s_addc_u32 s53, s17, 0
    s_sub_u32 s54, 1605632, s27
    s_mov_b32 s55, 0x20000
    s_mov_b32 s56, s24
    s_mov_b32 s57, s25
    s_mov_b32 s58, 12664832
    s_mov_b32 s59, 0x20000
    s_lshl_b32 s26, s71, 2
    s_add_u32 s26, s26, s69
    s_mul_i32 s27, s26, 147456
    s_lshl_b32 s97, s97, 6
    s_add_u32 s97, s97, s27
    s_lshl_b32 s73, s70, 11
    s_add_u32 s97, s97, s73
    s_lshl_b32 s98, s98, 6
    s_add_u32 s98, s98, s27
    s_lshl_b32 s73, s70, 11
    s_add_u32 s98, s98, s73
    s_lshl_b32 s99, s99, 6
    s_add_u32 s99, s99, s27
    s_lshl_b32 s73, s70, 11
    s_add_u32 s99, s99, s73
    s_cmp_lg_u32 s70, 0
    s_cbranch_scc1 KM_X0
    s_branch KM_X1
KM_X1:
    s_waitcnt vmcnt(8)
    v_mfma_f32_4x4x4_16b_bf16 v[60:63], v[56:57], v[80:81], 0
    v_mfma_f32_4x4x4_16b_bf16 v[68:71], v[80:81], v[80:81], 0
    v_mfma_f32_4x4x4_16b_bf16 v[64:67], v[56:57], v[82:83], 0
    v_mfma_f32_4x4x4_16b_bf16 v[72:75], v[82:83], v[82:83], 0
    s_waitcnt vmcnt(7)
    v_mfma_f32_4x4x4_16b_bf16 v[60:63], v[56:57], v[84:85], v[60:63]
    v_mfma_f32_4x4x4_16b_bf16 v[68:71], v[84:85], v[84:85], v[68:71]
    v_mfma_f32_4x4x4_16b_bf16 v[64:67], v[56:57], v[86:87], v[64:67]
    v_mfma_f32_4x4x4_16b_bf16 v[72:75], v[86:87], v[86:87], v[72:75]
    s_waitcnt vmcnt(6)
    v_mfma_f32_4x4x4_16b_bf16 v[60:63], v[56:57], v[88:89], v[60:63]
    v_mfma_f32_4x4x4_16b_bf16 v[68:71], v[88:89], v[88:89], v[68:71]
    v_mfma_f32_4x4x4_16b_bf16 v[64:67], v[56:57], v[90:91], v[64:67]
    v_mfma_f32_4x4x4_16b_bf16 v[72:75], v[90:91], v[90:91], v[72:75]
    s_waitcnt vmcnt(5)
    v_mfma_f32_4x4x4_16b_bf16 v[60:63], v[56:57], v[92:93], v[60:63]
    v_mfma_f32_4x4x4_16b_bf16 v[68:71], v[92:93], v[92:93], v[68:71]
    v_mfma_f32_4x4x4_16b_bf16 v[64:67], v[56:57], v[94:95], v[64:67]
    v_mfma_f32_4x4x4_16b_bf16 v[72:75], v[94:95], v[94:95], v[72:75]
    s_waitcnt vmcnt(2)
    v_mfma_f32_4x4x4_16b_bf16 v[60:63], v[56:57], v[96:97], v[60:63]
    v_mfma_f32_4x4x4_16b_bf16 v[68:71], v[96:97], v[96:97], v[68:71]
    v_mfma_f32_4x4x4_16b_bf16 v[64:67], v[56:57], v[98:99], v[64:67]
    v_mfma_f32_4x4x4_16b_bf16 v[72:75], v[98:99], v[98:99], v[72:75]
    s_waitcnt vmcnt(1)
    v_mfma_f32_4x4x4_16b_bf16 v[60:63], v[56:57], v[100:101], v[60:63]
    v_mfma_f32_4x4x4_16b_bf16 v[68:71], v[100:101], v[100:101], v[68:71]
    v_mfma_f32_4x4x4_16b_bf16 v[64:67], v[56:57], v[102:103], v[64:67]
    v_mfma_f32_4x4x4_16b_bf16 v[72:75], v[102:103], v[102:103], v[72:75]
    s_waitcnt vmcnt(0)
    v_mfma_f32_4x4x4_16b_bf16 v[60:63], v[56:57], v[104:105], v[60:63]
    v_mfma_f32_4x4x4_16b_bf16 v[68:71], v[104:105], v[104:105], v[68:71]
    v_mfma_f32_4x4x4_16b_bf16 v[64:67], v[56:57], v[106:107], v[64:67]
    v_mfma_f32_4x4x4_16b_bf16 v[72:75], v[106:107], v[106:107], v[72:75]
    buffer_load_dwordx4 v[108:111], v29, s[28:31], s76 offen
    buffer_load_dwordx4 v[112:115], v29, s[28:31], s77 offen
    buffer_load_dwordx4 v[116:119], v29, s[28:31], s78 offen
    buffer_load_dwordx4 v[120:123], v29, s[28:31], s79 offen
    buffer_load_dwordx4 v[124:127], v29, s[28:31], s80 offen
    buffer_load_dwordx4 v[128:131], v29, s[28:31], s81 offen
    buffer_load_dwordx4 v[132:135], v29, s[28:31], s82 offen
    s_mul_i32 s83, s76, 1344
    s_mul_i32 s76, s76, 1792
    s_mul_i32 s84, s77, 1344
    s_mul_i32 s77, s77, 1792
    s_mul_i32 s85, s78, 1344
    s_mul_i32 s78, s78, 1792
    s_mul_i32 s86, s79, 1344
    s_mul_i32 s79, s79, 1792
    s_mul_i32 s87, s80, 1344
    s_mul_i32 s80, s80, 1792
    s_mul_i32 s88, s81, 1344
    s_mul_i32 s81, s81, 1792
    s_mul_i32 s89, s82, 1344
    s_mul_i32 s82, s82, 1792
    v_add_f32 v60, v60, v64
    v_add_f32 v68, v68, v72
    v_add_f32 v69, v69, v73
    v_add_f32 v70, v70, v74
    v_add_f32 v71, v71, v75
    v_add_f32_dpp v60, v60, v60 quad_perm:[1,0,3,2] row_mask:0xf bank_mask:0xf
    v_cndmask_b32 v68, v69, v68, s[60:61]
    v_cndmask_b32 v70, v71, v70, s[60:61]
    v_add_f32_dpp v60, v60, v60 quad_perm:[2,3,0,1] row_mask:0xf bank_mask:0xf
    v_cndmask_b32 v44, v70, v68, s[62:63]
    s_nop 0
    v_add_f32_dpp v60, v60, v60 row_half_mirror row_mask:0xf bank_mask:0xf
    v_mul_f32 v38, 0xbb124925, v60
    v_cvt_pk_bf16_f32 v61, v38, v38
    v_and_b32 v76, 0xffff0000, v61
    v_and_b32 v77, 0xffff0000, v61
    v_and_b32 v78, 0xffff0000, v61
    v_and_b32 v79, 0xffff0000, v61
    s_nop 1
    v_mfma_f32_4x4x4_16b_bf16 v[136:139], v[58:59], v[80:81], v[76:79]
    v_mfma_f32_4x4x4_16b_bf16 v[140:143], v[58:59], v[82:83], v[76:79]
    v_mfma_f32_4x4x4_16b_bf16 v[144:147], v[58:59], v[84:85], v[76:79]
    s_nop 2
    v_cvt_pk_bf16_f32 v80, v136, v137
    v_cvt_pk_bf16_f32 v81, v138, v139
    v_mfma_f32_4x4x4_16b_bf16 v[148:151], v[58:59], v[86:87], v[76:79]
    v_cvt_pk_bf16_f32 v82, v140, v141
    v_cvt_pk_bf16_f32 v83, v142, v143
    ds_write_b128 v40, v[80:83] offset:0
    v_mfma_f32_4x4x4_16b_bf16 v[136:139], v[58:59], v[88:89], v[76:79]
    v_cvt_pk_bf16_f32 v84, v144, v145
    v_cvt_pk_bf16_f32 v85, v146, v147
    v_mfma_f32_4x4x4_16b_bf16 v[140:143], v[58:59], v[90:91], v[76:79]
    v_cvt_pk_bf16_f32 v86, v148, v149
    v_cvt_pk_bf16_f32 v87, v150, v151
    ds_write_b128 v40, v[84:87] offset:16384
    v_mfma_f32_4x4x4_16b_bf16 v[144:147], v[58:59], v[92:93], v[76:79]
    v_cvt_pk_bf16_f32 v88, v136, v137
    v_cvt_pk_bf16_f32 v89, v138, v139
    v_mfma_f32_4x4x4_16b_bf16 v[148:151], v[58:59], v[94:95], v[76:79]
    v_cvt_pk_bf16_f32 v90, v140, v141
    v_cvt_pk_bf16_f32 v91, v142, v143
    ds_write_b128 v40, v[88:91] offset:32768
    v_mfma_f32_4x4x4_16b_bf16 v[136:139], v[58:59], v[96:97], v[76:79]
    v_cvt_pk_bf16_f32 v92, v144, v145
    v_cvt_pk_bf16_f32 v93, v146, v147
    v_mfma_f32_4x4x4_16b_bf16 v[140:143], v[58:59], v[98:99], v[76:79]
    v_cvt_pk_bf16_f32 v94, v148, v149
    v_cvt_pk_bf16_f32 v95, v150, v151
    ds_write_b128 v40, v[92:95] offset:49152
    v_mfma_f32_4x4x4_16b_bf16 v[144:147], v[58:59], v[100:101], v[76:79]
    v_cvt_pk_bf16_f32 v96, v136, v137
    v_cvt_pk_bf16_f32 v97, v138, v139
    v_mfma_f32_4x4x4_16b_bf16 v[148:151], v[58:59], v[102:103], v[76:79]
    v_cvt_pk_bf16_f32 v98, v140, v141
    v_cvt_pk_bf16_f32 v99, v142, v143
    ds_write_b128 v41, v[96:99] offset:0
    v_mfma_f32_4x4x4_16b_bf16 v[136:139], v[58:59], v[104:105], v[76:79]
    v_cvt_pk_bf16_f32 v100, v144, v145
    v_cvt_pk_bf16_f32 v101, v146, v147
    v_mfma_f32_4x4x4_16b_bf16 v[140:143], v[58:59], v[106:107], v[76:79]
    v_cvt_pk_bf16_f32 v102, v148, v149
    v_cvt_pk_bf16_f32 v103, v150, v151
    ds_write_b128 v41, v[100:103] offset:16384
    v_cvt_pk_bf16_f32 v104, v136, v137
    v_cvt_pk_bf16_f32 v105, v138, v139
    v_cvt_pk_bf16_f32 v106, v140, v141
    v_cvt_pk_bf16_f32 v107, v142, v143
    ds_write_b128 v41, v[104:107] offset:32768
    s_waitcnt vmcnt(6)
    v_mfma_f32_4x4x4_16b_bf16 v[60:63], v[56:57], v[108:109], 0
    v_mfma_f32_4x4x4_16b_bf16 v[68:71], v[108:109], v[108:109], 0
    v_mfma_f32_4x4x4_16b_bf16 v[64:67], v[56:57], v[110:111], 0
    v_mfma_f32_4x4x4_16b_bf16 v[72:75], v[110:111], v[110:111], 0
    s_waitcnt vmcnt(5)
    v_mfma_f32_4x4x4_16b_bf16 v[60:63], v[56:57], v[112:113], v[60:63]
    v_mfma_f32_4x4x4_16b_bf16 v[68:71], v[112:113], v[112:113], v[68:71]
    v_mfma_f32_4x4x4_16b_bf16 v[64:67], v[56:57], v[114:115], v[64:67]
    v_mfma_f32_4x4x4_16b_bf16 v[72:75], v[114:115], v[114:115], v[72:75]
    s_waitcnt vmcnt(4)
    v_mfma_f32_4x4x4_16b_bf16 v[60:63], v[56:57], v[116:117], v[60:63]
    v_mfma_f32_4x4x4_16b_bf16 v[68:71], v[116:117], v[116:117], v[68:71]
    v_mfma_f32_4x4x4_16b_bf16 v[64:67], v[56:57], v[118:119], v[64:67]
    v_mfma_f32_4x4x4_16b_bf16 v[72:75], v[118:119], v[118:119], v[72:75]
    s_waitcnt vmcnt(3)
    v_mfma_f32_4x4x4_16b_bf16 v[60:63], v[56:57], v[120:121], v[60:63]
    v_mfma_f32_4x4x4_16b_bf16 v[68:71], v[120:121], v[120:121], v[68:71]
    v_mfma_f32_4x4x4_16b_bf16 v[64:67], v[56:57], v[122:123], v[64:67]
    v_mfma_f32_4x4x4_16b_bf16 v[72:75], v[122:123], v[122:123], v[72:75]
    s_waitcnt vmcnt(2)
    v_mfma_f32_4x4x4_16b_bf16 v[60:63], v[56:57], v[124:125], v[60:63]
    v_mfma_f32_4x4x4_16b_bf16 v[68:71], v[124:125], v[124:125], v[68:71]
    v_mfma_f32_4x4x4_16b_bf16 v[64:67], v[56:57], v[126:127], v[64:67]
    v_mfma_f32_4x4x4_16b_bf16 v[72:75], v[126:127], v[126:127], v[72:75]
    s_waitcnt vmcnt(1)
    v_mfma_f32_4x4x4_16b_bf16 v[60:63], v[56:57], v[128:129], v[60:63]
    v_mfma_f32_4x4x4_16b_bf16 v[68:71], v[128:129], v[128:129], v[68:71]
    v_mfma_f32_4x4x4_16b_bf16 v[64:67], v[56:57], v[130:131], v[64:67]
    v_mfma_f32_4x4x4_16b_bf16 v[72:75], v[130:131], v[130:131], v[72:75]
    s_waitcnt vmcnt(0)
    v_mfma_f32_4x4x4_16b_bf16 v[60:63], v[56:57], v[132:133], v[60:63]
    v_mfma_f32_4x4x4_16b_bf16 v[68:71], v[132:133], v[132:133], v[68:71]
    v_mfma_f32_4x4x4_16b_bf16 v[64:67], v[56:57], v[134:135], v[64:67]
    v_mfma_f32_4x4x4_16b_bf16 v[72:75], v[134:135], v[134:135], v[72:75]
    s_bitcmp1_b32 s2, 5
    s_cbranch_scc1 KM_DH
    s_add_u32 m0, s75, 131072
    s_nop 0
    buffer_load_dwordx4 v2, s[32:35], s77 offen lds
    s_add_u32 s3, s77, 114688
    s_add_u32 m0, s75, 135168
    s_nop 0
    buffer_load_dwordx4 v2, s[32:35], s3 offen lds
    s_add_u32 m0, s75, 139264
    s_nop 0
    buffer_load_dwordx4 v3, s[36:39], s77 offen lds
    s_add_u32 s3, s77, 114688
    s_add_u32 m0, s75, 143360
    s_nop 0
    buffer_load_dwordx4 v3, s[36:39], s3 offen lds
    s_add_u32 m0, s75, 147456
    s_nop 0
    buffer_load_dwordx4 v2, s[32:35], s78 offen lds
    s_add_u32 s3, s78, 114688
    s_add_u32 m0, s75, 151552
    s_nop 0
    buffer_load_dwordx4 v2, s[32:35], s3 offen lds
    s_add_u32 m0, s75, 155648
    s_nop 0
    buffer_load_dwordx4 v3, s[36:39], s78 offen lds
    s_add_u32 s3, s78, 114688
    s_add_u32 m0, s75, 159744
    s_nop 0
    buffer_load_dwordx4 v3, s[36:39], s3 offen lds
KM_DR:
    v_add_f32 v60, v60, v64
    v_add_f32 v68, v68, v72
    v_add_f32 v69, v69, v73
    v_add_f32 v70, v70, v74
    v_add_f32 v71, v71, v75
    v_add_f32_dpp v60, v60, v60 quad_perm:[1,0,3,2] row_mask:0xf bank_mask:0xf
    v_cndmask_b32 v68, v69, v68, s[60:61]
    v_cndmask_b32 v70, v71, v70, s[60:61]
    v_add_f32_dpp v60, v60, v60 quad_perm:[2,3,0,1] row_mask:0xf bank_mask:0xf
    v_cndmask_b32 v45, v70, v68, s[62:63]
    s_nop 0
    v_add_f32_dpp v60, v60, v60 row_half_mirror row_mask:0xf bank_mask:0xf
    v_mul_f32 v39, 0xbb124925, v60
    v_cvt_pk_bf16_f32 v61, v39, v39
    v_and_b32 v76, 0xffff0000, v61
    v_and_b32 v77, 0xffff0000, v61
    v_and_b32 v78, 0xffff0000, v61
    v_and_b32 v79, 0xffff0000, v61
    s_nop 1
    v_mfma_f32_4x4x4_16b_bf16 v[136:139], v[58:59], v[108:109], v[76:79]
    v_mfma_f32_4x4x4_16b_bf16 v[140:143], v[58:59], v[110:111], v[76:79]
    v_mfma_f32_4x4x4_16b_bf16 v[144:147], v[58:59], v[112:113], v[76:79]
    s_nop 2
    v_cvt_pk_bf16_f32 v108, v136, v137
    v_cvt_pk_bf16_f32 v109, v138, v139
    v_mfma_f32_4x4x4_16b_bf16 v[148:151], v[58:59], v[114:115], v[76:79]
    v_cvt_pk_bf16_f32 v110, v140, v141
    v_cvt_pk_bf16_f32 v111, v142, v143
    ds_write_b128 v42, v[108:111] offset:0
    v_mfma_f32_4x4x4_16b_bf16 v[136:139], v[58:59], v[116:117], v[76:79]
    v_cvt_pk_bf16_f32 v112, v144, v145
    v_cvt_pk_bf16_f32 v113, v146, v147
    v_mfma_f32_4x4x4_16b_bf16 v[140:143], v[58:59], v[118:119], v[76:79]
    v_cvt_pk_bf16_f32 v114, v148, v149
    v_cvt_pk_bf16_f32 v115, v150, v151
    ds_write_b128 v42, v[112:115] offset:16384
    v_mfma_f32_4x4x4_16b_bf16 v[144:147], v[58:59], v[120:121], v[76:79]
    v_cvt_pk_bf16_f32 v116, v136, v137
    v_cvt_pk_bf16_f32 v117, v138, v139
    v_mfma_f32_4x4x4_16b_bf16 v[148:151], v[58:59], v[122:123], v[76:79]
    v_cvt_pk_bf16_f32 v118, v140, v141
    v_cvt_pk_bf16_f32 v119, v142, v143
    ds_write_b128 v42, v[116:119] offset:32768
    v_mfma_f32_4x4x4_16b_bf16 v[136:139], v[58:59], v[124:125], v[76:79]
    v_cvt_pk_bf16_f32 v120, v144, v145
    v_cvt_pk_bf16_f32 v121, v146, v147
    v_mfma_f32_4x4x4_16b_bf16 v[140:143], v[58:59], v[126:127], v[76:79]
    v_cvt_pk_bf16_f32 v122, v148, v149
    v_cvt_pk_bf16_f32 v123, v150, v151
    ds_write_b128 v42, v[120:123] offset:49152
    v_mfma_f32_4x4x4_16b_bf16 v[144:147], v[58:59], v[128:129], v[76:79]
    v_cvt_pk_bf16_f32 v124, v136, v137
    v_cvt_pk_bf16_f32 v125, v138, v139
    v_mfma_f32_4x4x4_16b_bf16 v[148:151], v[58:59], v[130:131], v[76:79]
    v_cvt_pk_bf16_f32 v126, v140, v141
    v_cvt_pk_bf16_f32 v127, v142, v143
    ds_write_b128 v43, v[124:127] offset:0
    v_mfma_f32_4x4x4_16b_bf16 v[136:139], v[58:59], v[132:133], v[76:79]
    v_cvt_pk_bf16_f32 v128, v144, v145
    v_cvt_pk_bf16_f32 v129, v146, v147
    v_mfma_f32_4x4x4_16b_bf16 v[140:143], v[58:59], v[134:135], v[76:79]
    v_cvt_pk_bf16_f32 v130, v148, v149
    v_cvt_pk_bf16_f32 v131, v150, v151
    ds_write_b128 v43, v[128:131] offset:16384
    v_cvt_pk_bf16_f32 v132, v136, v137
    v_cvt_pk_bf16_f32 v133, v138, v139
    v_cvt_pk_bf16_f32 v134, v140, v141
    v_cvt_pk_bf16_f32 v135, v142, v143
    ds_write_b128 v43, v[132:135] offset:32768
    s_branch KM_LE
KM_DH:
    s_add_u32 m0, s75, 122880
    s_nop 0
    buffer_load_dwordx4 v4, s[32:35], s84 offen lds
    s_add_u32 s3, s84, 86016
    s_add_u32 m0, s75, 126976
    s_nop 0
    buffer_load_dwordx4 v4, s[32:35], s3 offen lds
    s_add_u32 m0, s75, 131072
    s_nop 0
    buffer_load_dwordx4 v4, s[32:35], s85 offen lds
    s_add_u32 s3, s85, 86016
    s_add_u32 m0, s75, 135168
    s_nop 0
    buffer_load_dwordx4 v4, s[32:35], s3 offen lds
    s_add_u32 m0, s75, 139264
    s_nop 0
    buffer_load_dwordx4 v4, s[32:35], s86 offen lds
    s_add_u32 s3, s86, 86016
    s_add_u32 m0, s75, 143360
    s_nop 0
    buffer_load_dwordx4 v4, s[32:35], s3 offen lds
    s_add_u32 m0, s75, 147456
    s_nop 0
    buffer_load_dwordx4 v4, s[32:35], s87 offen lds
    s_add_u32 s3, s87, 86016
    s_add_u32 m0, s75, 151552
    s_nop 0
    buffer_load_dwordx4 v4, s[32:35], s3 offen lds
    s_branch KM_DR
KM_X0:
    buffer_load_dwordx4 v[80:83], v28, s[28:31], s76 offen
    buffer_load_dwordx4 v[84:87], v28, s[28:31], s77 offen
    buffer_load_dwordx4 v[88:91], v28, s[28:31], s78 offen
    buffer_load_dwordx4 v[92:95], v28, s[28:31], s79 offen
    buffer_load_dwordx4 v[96:99], v28, s[28:31], s80 offen
    buffer_load_dwordx4 v[100:103], v28, s[28:31], s81 offen
    buffer_load_dwordx4 v[104:107], v28, s[28:31], s82 offen
    s_waitcnt vmcnt(6)
    v_mfma_f32_4x4x4_16b_bf16 v[60:63], v[56:57], v[80:81], 0
    v_mfma_f32_4x4x4_16b_bf16 v[68:71], v[80:81], v[80:81], 0
    v_mfma_f32_4x4x4_16b_bf16 v[64:67], v[56:57], v[82:83], 0
    v_mfma_f32_4x4x4_16b_bf16 v[72:75], v[82:83], v[82:83], 0
    s_waitcnt vmcnt(5)
    v_mfma_f32_4x4x4_16b_bf16 v[60:63], v[56:57], v[84:85], v[60:63]
    v_mfma_f32_4x4x4_16b_bf16 v[68:71], v[84:85], v[84:85], v[68:71]
    v_mfma_f32_4x4x4_16b_bf16 v[64:67], v[56:57], v[86:87], v[64:67]
    v_mfma_f32_4x4x4_16b_bf16 v[72:75], v[86:87], v[86:87], v[72:75]
    s_waitcnt vmcnt(4)
    v_mfma_f32_4x4x4_16b_bf16 v[60:63], v[56:57], v[88:89], v[60:63]
    v_mfma_f32_4x4x4_16b_bf16 v[68:71], v[88:89], v[88:89], v[68:71]
    v_mfma_f32_4x4x4_16b_bf16 v[64:67], v[56:57], v[90:91], v[64:67]
    v_mfma_f32_4x4x4_16b_bf16 v[72:75], v[90:91], v[90:91], v[72:75]
    s_waitcnt vmcnt(3)
    v_mfma_f32_4x4x4_16b_bf16 v[60:63], v[56:57], v[92:93], v[60:63]
    v_mfma_f32_4x4x4_16b_bf16 v[68:71], v[92:93], v[92:93], v[68:71]
    v_mfma_f32_4x4x4_16b_bf16 v[64:67], v[56:57], v[94:95], v[64:67]
    v_mfma_f32_4x4x4_16b_bf16 v[72:75], v[94:95], v[94:95], v[72:75]
    s_waitcnt vmcnt(2)
    v_mfma_f32_4x4x4_16b_bf16 v[60:63], v[56:57], v[96:97], v[60:63]
    v_mfma_f32_4x4x4_16b_bf16 v[68:71], v[96:97], v[96:97], v[68:71]
    v_mfma_f32_4x4x4_16b_bf16 v[64:67], v[56:57], v[98:99], v[64:67]
    v_mfma_f32_4x4x4_16b_bf16 v[72:75], v[98:99], v[98:99], v[72:75]
    s_waitcnt vmcnt(1)
    v_mfma_f32_4x4x4_16b_bf16 v[60:63], v[56:57], v[100:101], v[60:63]
    v_mfma_f32_4x4x4_16b_bf16 v[68:71], v[100:101], v[100:101], v[68:71]
    v_mfma_f32_4x4x4_16b_bf16 v[64:67], v[56:57], v[102:103], v[64:67]
    v_mfma_f32_4x4x4_16b_bf16 v[72:75], v[102:103], v[102:103], v[72:75]
    s_waitcnt vmcnt(0)
    v_mfma_f32_4x4x4_16b_bf16 v[60:63], v[56:57], v[104:105], v[60:63]
    v_mfma_f32_4x4x4_16b_bf16 v[68:71], v[104:105], v[104:105], v[68:71]
    v_mfma_f32_4x4x4_16b_bf16 v[64:67], v[56:57], v[106:107], v[64:67]
    v_mfma_f32_4x4x4_16b_bf16 v[72:75], v[106:107], v[106:107], v[72:75]
    buffer_load_dwordx4 v[108:111], v29, s[28:31], s76 offen
    buffer_load_dwordx4 v[112:115], v29, s[28:31], s77 offen
    buffer_load_dwordx4 v[116:119], v29, s[28:31], s78 offen
    buffer_load_dwordx4 v[120:123], v29, s[28:31], s79 offen
    buffer_load_dwordx4 v[124:127], v29, s[28:31], s80 offen
    buffer_load_dwordx4 v[128:131], v29, s[28:31], s81 offen
    buffer_load_dwordx4 v[132:135], v29, s[28:31], s82 offen
    s_mul_i32 s83, s76, 1344
    s_mul_i32 s76, s76, 1792
    s_mul_i32 s84, s77, 1344
    s_mul_i32 s77, s77, 1792
    s_mul_i32 s85, s78, 1344
    s_mul_i32 s78, s78, 1792
    s_mul_i32 s86, s79, 1344
    s_mul_i32 s79, s79, 1792
    s_mul_i32 s87, s80, 1344
    s_mul_i32 s80, s80, 1792
    s_mul_i32 s88, s81, 1344
    s_mul_i32 s81, s81, 1792
    s_mul_i32 s89, s82, 1344
    s_mul_i32 s82, s82, 1792
    v_add_f32 v60, v60, v64
    v_add_f32 v68, v68, v72
    v_add_f32 v69, v69, v73
    v_add_f32 v70, v70, v74
    v_add_f32 v71, v71, v75
    v_add_f32_dpp v60, v60, v60 quad_perm:[1,0,3,2] row_mask:0xf bank_mask:0xf
    v_cndmask_b32 v68, v69, v68, s[60:61]
    v_cndmask_b32 v70, v71, v70, s[60:61]
    v_add_f32_dpp v60, v60, v60 quad_perm:[2,3,0,1] row_mask:0xf bank_mask:0xf
    v_cndmask_b32 v44, v70, v68, s[62:63]
    s_nop 0
    v_add_f32_dpp v60, v60, v60 row_half_mirror row_mask:0xf bank_mask:0xf
    v_mul_f32 v38, 0xbb124925, v60
    v_cvt_pk_bf16_f32 v61, v38, v38
    v_and_b32 v76, 0xffff0000, v61
    v_and_b32 v77, 0xffff0000, v61
    v_and_b32 v78, 0xffff0000, v61
    v_and_b32 v79, 0xffff0000, v61
    s_nop 1
    v_mfma_f32_4x4x4_16b_bf16 v[136:139], v[58:59], v[80:81], v[76:79]
    v_mfma_f32_4x4x4_16b_bf16 v[140:143], v[58:59], v[82:83], v[76:79]
    v_mfma_f32_4x4x4_16b_bf16 v[144:147], v[58:59], v[84:85], v[76:79]
    s_nop 2
    v_cvt_pk_bf16_f32 v80, v136, v137
    v_cvt_pk_bf16_f32 v81, v138, v139
    v_mfma_f32_4x4x4_16b_bf16 v[148:151], v[58:59], v[86:87], v[76:79]
    v_cvt_pk_bf16_f32 v82, v140, v141
    v_cvt_pk_bf16_f32 v83, v142, v143
    ds_write_b128 v40, v[80:83] offset:0
    v_mfma_f32_4x4x4_16b_bf16 v[136:139], v[58:59], v[88:89], v[76:79]
    v_cvt_pk_bf16_f32 v84, v144, v145
    v_cvt_pk_bf16_f32 v85, v146, v147
    v_mfma_f32_4x4x4_16b_bf16 v[140:143], v[58:59], v[90:91], v[76:79]
    v_cvt_pk_bf16_f32 v86, v148, v149
    v_cvt_pk_bf16_f32 v87, v150, v151
    ds_write_b128 v40, v[84:87] offset:16384
    v_mfma_f32_4x4x4_16b_bf16 v[144:147], v[58:59], v[92:93], v[76:79]
    v_cvt_pk_bf16_f32 v88, v136, v137
    v_cvt_pk_bf16_f32 v89, v138, v139
    v_mfma_f32_4x4x4_16b_bf16 v[148:151], v[58:59], v[94:95], v[76:79]
    v_cvt_pk_bf16_f32 v90, v140, v141
    v_cvt_pk_bf16_f32 v91, v142, v143
    ds_write_b128 v40, v[88:91] offset:32768
    v_mfma_f32_4x4x4_16b_bf16 v[136:139], v[58:59], v[96:97], v[76:79]
    v_cvt_pk_bf16_f32 v92, v144, v145
    v_cvt_pk_bf16_f32 v93, v146, v147
    v_mfma_f32_4x4x4_16b_bf16 v[140:143], v[58:59], v[98:99], v[76:79]
    v_cvt_pk_bf16_f32 v94, v148, v149
    v_cvt_pk_bf16_f32 v95, v150, v151
    ds_write_b128 v40, v[92:95] offset:49152
    v_mfma_f32_4x4x4_16b_bf16 v[144:147], v[58:59], v[100:101], v[76:79]
    v_cvt_pk_bf16_f32 v96, v136, v137
    v_cvt_pk_bf16_f32 v97, v138, v139
    v_mfma_f32_4x4x4_16b_bf16 v[148:151], v[58:59], v[102:103], v[76:79]
    v_cvt_pk_bf16_f32 v98, v140, v141
    v_cvt_pk_bf16_f32 v99, v142, v143
    ds_write_b128 v41, v[96:99] offset:0
    v_mfma_f32_4x4x4_16b_bf16 v[136:139], v[58:59], v[104:105], v[76:79]
    v_cvt_pk_bf16_f32 v100, v144, v145
    v_cvt_pk_bf16_f32 v101, v146, v147
    v_mfma_f32_4x4x4_16b_bf16 v[140:143], v[58:59], v[106:107], v[76:79]
    v_cvt_pk_bf16_f32 v102, v148, v149
    v_cvt_pk_bf16_f32 v103, v150, v151
    ds_write_b128 v41, v[100:103] offset:16384
    v_cvt_pk_bf16_f32 v104, v136, v137
    v_cvt_pk_bf16_f32 v105, v138, v139
    v_cvt_pk_bf16_f32 v106, v140, v141
    v_cvt_pk_bf16_f32 v107, v142, v143
    ds_write_b128 v41, v[104:107] offset:32768
    s_waitcnt vmcnt(6)
    v_mfma_f32_4x4x4_16b_bf16 v[60:63], v[56:57], v[108:109], 0
    v_mfma_f32_4x4x4_16b_bf16 v[68:71], v[108:109], v[108:109], 0
    v_mfma_f32_4x4x4_16b_bf16 v[64:67], v[56:57], v[110:111], 0
    v_mfma_f32_4x4x4_16b_bf16 v[72:75], v[110:111], v[110:111], 0
    s_waitcnt vmcnt(5)
    v_mfma_f32_4x4x4_16b_bf16 v[60:63], v[56:57], v[112:113], v[60:63]
    v_mfma_f32_4x4x4_16b_bf16 v[68:71], v[112:113], v[112:113], v[68:71]
    v_mfma_f32_4x4x4_16b_bf16 v[64:67], v[56:57], v[114:115], v[64:67]
    v_mfma_f32_4x4x4_16b_bf16 v[72:75], v[114:115], v[114:115], v[72:75]
    s_waitcnt vmcnt(4)
    v_mfma_f32_4x4x4_16b_bf16 v[60:63], v[56:57], v[116:117], v[60:63]
    v_mfma_f32_4x4x4_16b_bf16 v[68:71], v[116:117], v[116:117], v[68:71]
    v_mfma_f32_4x4x4_16b_bf16 v[64:67], v[56:57], v[118:119], v[64:67]
    v_mfma_f32_4x4x4_16b_bf16 v[72:75], v[118:119], v[118:119], v[72:75]
    s_waitcnt vmcnt(3)
    v_mfma_f32_4x4x4_16b_bf16 v[60:63], v[56:57], v[120:121], v[60:63]
    v_mfma_f32_4x4x4_16b_bf16 v[68:71], v[120:121], v[120:121], v[68:71]
    v_mfma_f32_4x4x4_16b_bf16 v[64:67], v[56:57], v[122:123], v[64:67]
    v_mfma_f32_4x4x4_16b_bf16 v[72:75], v[122:123], v[122:123], v[72:75]
    s_waitcnt vmcnt(2)
    v_mfma_f32_4x4x4_16b_bf16 v[60:63], v[56:57], v[124:125], v[60:63]
    v_mfma_f32_4x4x4_16b_bf16 v[68:71], v[124:125], v[124:125], v[68:71]
    v_mfma_f32_4x4x4_16b_bf16 v[64:67], v[56:57], v[126:127], v[64:67]
    v_mfma_f32_4x4x4_16b_bf16 v[72:75], v[126:127], v[126:127], v[72:75]
    s_waitcnt vmcnt(1)
    v_mfma_f32_4x4x4_16b_bf16 v[60:63], v[56:57], v[128:129], v[60:63]
    v_mfma_f32_4x4x4_16b_bf16 v[68:71], v[128:129], v[128:129], v[68:71]
    v_mfma_f32_4x4x4_16b_bf16 v[64:67], v[56:57], v[130:131], v[64:67]
    v_mfma_f32_4x4x4_16b_bf16 v[72:75], v[130:131], v[130:131], v[72:75]
    s_waitcnt vmcnt(0)
    v_mfma_f32_4x4x4_16b_bf16 v[60:63], v[56:57], v[132:133], v[60:63]
    v_mfma_f32_4x4x4_16b_bf16 v[68:71], v[132:133], v[132:133], v[68:71]
    v_mfma_f32_4x4x4_16b_bf16 v[64:67], v[56:57], v[134:135], v[64:67]
    v_mfma_f32_4x4x4_16b_bf16 v[72:75], v[134:135], v[134:135], v[72:75]
    s_nop 3
    v_add_f32 v60, v60, v64
    v_add_f32 v68, v68, v72
    v_add_f32 v69, v69, v73
    v_add_f32 v70, v70, v74
    v_add_f32 v71, v71, v75
    v_add_f32_dpp v60, v60, v60 quad_perm:[1,0,3,2] row_mask:0xf bank_mask:0xf
    v_cndmask_b32 v68, v69, v68, s[60:61]
    v_cndmask_b32 v70, v71, v70, s[60:61]
    v_add_f32_dpp v60, v60, v60 quad_perm:[2,3,0,1] row_mask:0xf bank_mask:0xf
    v_cndmask_b32 v45, v70, v68, s[62:63]
    s_nop 0
    v_add_f32_dpp v60, v60, v60 row_half_mirror row_mask:0xf bank_mask:0xf
    v_mul_f32 v39, 0xbb124925, v60
    v_cvt_pk_bf16_f32 v61, v39, v39
    v_and_b32 v76, 0xffff0000, v61
    v_and_b32 v77, 0xffff0000, v61
    v_and_b32 v78, 0xffff0000, v61
    v_and_b32 v79, 0xffff0000, v61
    s_nop 1
    v_mfma_f32_4x4x4_16b_bf16 v[136:139], v[58:59], v[108:109], v[76:79]
    v_mfma_f32_4x4x4_16b_bf16 v[140:143], v[58:59], v[110:111], v[76:79]
    v_mfma_f32_4x4x4_16b_bf16 v[144:147], v[58:59], v[112:113], v[76:79]
    s_nop 2
    v_cvt_pk_bf16_f32 v108, v136, v137
    v_cvt_pk_bf16_f32 v109, v138, v139
    v_mfma_f32_4x4x4_16b_bf16 v[148:151], v[58:59], v[114:115], v[76:79]
    v_cvt_pk_bf16_f32 v110, v140, v141
    v_cvt_pk_bf16_f32 v111, v142, v143
    ds_write_b128 v42, v[108:111] offset:0
    v_mfma_f32_4x4x4_16b_bf16 v[136:139], v[58:59], v[116:117], v[76:79]
    v_cvt_pk_bf16_f32 v112, v144, v145
    v_cvt_pk_bf16_f32 v113, v146, v147
    v_mfma_f32_4x4x4_16b_bf16 v[140:143], v[58:59], v[118:119], v[76:79]
    v_cvt_pk_bf16_f32 v114, v148, v149
    v_cvt_pk_bf16_f32 v115, v150, v151
    ds_write_b128 v42, v[112:115] offset:16384
    v_mfma_f32_4x4x4_16b_bf16 v[144:147], v[58:59], v[120:121], v[76:79]
    v_cvt_pk_bf16_f32 v116, v136, v137
    v_cvt_pk_bf16_f32 v117, v138, v139
    v_mfma_f32_4x4x4_16b_bf16 v[148:151], v[58:59], v[122:123], v[76:79]
    v_cvt_pk_bf16_f32 v118, v140, v141
    v_cvt_pk_bf16_f32 v119, v142, v143
    ds_write_b128 v42, v[116:119] offset:32768
    v_mfma_f32_4x4x4_16b_bf16 v[136:139], v[58:59], v[124:125], v[76:79]
    v_cvt_pk_bf16_f32 v120, v144, v145
    v_cvt_pk_bf16_f32 v121, v146, v147
    v_mfma_f32_4x4x4_16b_bf16 v[140:143], v[58:59], v[126:127], v[76:79]
    v_cvt_pk_bf16_f32 v122, v148, v149
    v_cvt_pk_bf16_f32 v123, v150, v151
    ds_write_b128 v42, v[120:123] offset:49152
    v_mfma_f32_4x4x4_16b_bf16 v[144:147], v[58:59], v[128:129], v[76:79]
    v_cvt_pk_bf16_f32 v124, v136, v137
    v_cvt_pk_bf16_f32 v125, v138, v139
    v_mfma_f32_4x4x4_16b_bf16 v[148:151], v[58:59], v[130:131], v[76:79]
    v_cvt_pk_bf16_f32 v126, v140, v141
    v_cvt_pk_bf16_f32 v127, v142, v143
    ds_write_b128 v43, v[124:127] offset:0
    v_mfma_f32_4x4x4_16b_bf16 v[136:139], v[58:59], v[132:133], v[76:79]
    v_cvt_pk_bf16_f32 v128, v144, v145
    v_cvt_pk_bf16_f32 v129, v146, v147
    v_mfma_f32_4x4x4_16b_bf16 v[140:143], v[58:59], v[134:135], v[76:79]
    v_cvt_pk_bf16_f32 v130, v148, v149
    v_cvt_pk_bf16_f32 v131, v150, v151
    ds_write_b128 v43, v[128:131] offset:16384
    v_cvt_pk_bf16_f32 v132, v136, v137
    v_cvt_pk_bf16_f32 v133, v138, v139
    v_cvt_pk_bf16_f32 v134, v140, v141
    v_cvt_pk_bf16_f32 v135, v142, v143
    ds_write_b128 v43, v[132:135] offset:32768
KM_LE:
    s_bitcmp1_b32 s2, 5
    s_cbranch_scc1 KM_H
    v_lshlrev_b32 v46, 2, v32
    v_add_u32 v46, 110592, v46
    s_mov_b32 s60, s22
    s_mov_b32 s61, s23
    s_mov_b32 s62, 256
    s_mov_b32 s63, 0x20000
    s_cmp_lg_u32 s70, 0
    s_cbranch_scc1 KM_BF
    s_lshr_b32 s26, s68, 1
    s_or_b32 s26, s2, s26
    s_cmp_eq_u32 s26, 0
    s_cselect_b32 s26, 0, 0x40000000
    s_add_u32 s26, s26, 12648448
    v_lshlrev_b32 v34, 7, v0
    v_mov_b32 v35, 0
    buffer_store_dword v35, v34, s[56:59], s26 offen sc0 sc1
    s_lshr_b32 s26, s2, 6
    s_lshl_b32 s26, s26, 5
    s_and_b32 s3, s2, 31
    s_add_u32 s26, s26, s3
    v_xor_b32 v33, 128, v0
    s_mov_b32 s64, s6
    s_mov_b32 s65, s7
    s_mov_b32 s66, 1204224
    s_mov_b32 s67, 0x20000
    s_mul_i32 s3, s26, 9472
    v_add_u32 v35, 438, v33
    v_lshlrev_b32 v34, 7, v33
    v_lshrrev_b32 v35, 9, v35
    v_lshl_add_u32 v34, v35, 22, v34
    buffer_load_dword v252, v34, s[64:67], s3 offen
    s_mov_b32 s64, s14
    s_mov_b32 s65, s15
    s_mov_b32 s66, 1605632
    s_mov_b32 s67, 0x20000
    s_mul_i32 s3, s26, 12544
    v_add_u32 v35, 414, v0
    v_lshlrev_b32 v34, 7, v0
    v_lshrrev_b32 v35, 9, v35
    v_lshl_add_u32 v34, v35, 22, v34
    buffer_load_dword v250, v34, s[64:67], s3 offen
    s_mov_b32 s64, s16
    s_mov_b32 s65, s17
    s_mov_b32 s66, 1605632
    s_mov_b32 s67, 0x20000
    s_mul_i32 s3, s26, 12544
    v_add_u32 v35, 414, v33
    v_lshlrev_b32 v34, 7, v33
    v_lshrrev_b32 v35, 9, v35
    v_lshl_add_u32 v34, v35, 22, v34
    buffer_load_dword v251, v34, s[64:67], s3 offen
KM_BF:
    s_nop 1
    s_waitcnt lgkmcnt(0)
    s_barrier
    v_add_u32 v8, 114688, v6
    v_xor_b32 v9, 32, v8
    ds_read_b64_tr_b16 v[56:57], v8 offset:0
    ds_read_b64_tr_b16 v[58:59], v8 offset:512
    ds_read_b128 v[144:147], v11 offset:0
    ds_read_b64_tr_b16 v[60:61], v9 offset:8192
    ds_read_b64_tr_b16 v[62:63], v9 offset:8704
    ds_read_b128 v[148:151], v12 offset:0
    ds_read_b64_tr_b16 v[64:65], v8 offset:2048
    ds_read_b64_tr_b16 v[66:67], v8 offset:2560
    ds_read_b128 v[152:155], v13 offset:0
    ds_read_b64_tr_b16 v[68:69], v9 offset:10240
    ds_read_b64_tr_b16 v[70:71], v9 offset:10752
    ds_read_b128 v[156:159], v14 offset:0
    ds_read_b64_tr_b16 v[72:73], v8 offset:4096
    ds_read_b64_tr_b16 v[74:75], v8 offset:4608
    s_waitcnt lgkmcnt(11)
    v_mfma_f32_32x32x16_bf16 v[80:95], v[56:59], v[144:147], 0
    s_setprio 1
    ds_read_b64_tr_b16 v[76:77], v9 offset:12288
    ds_read_b64_tr_b16 v[78:79], v9 offset:12800
    ds_read_b128 v[160:163], v11 offset:16384
    s_waitcnt lgkmcnt(12)
    v_mfma_f32_32x32x16_bf16 v[96:111], v[60:63], v[144:147], 0
    ds_read_b64_tr_b16 v[56:57], v8 offset:6144
    ds_read_b64_tr_b16 v[58:59], v8 offset:6656
    s_waitcnt lgkmcnt(11)
    v_mfma_f32_32x32x16_bf16 v[80:95], v[64:67], v[148:151], v[80:95]
    s_setprio 0
    ds_read_b64_tr_b16 v[60:61], v9 offset:14336
    ds_read_b64_tr_b16 v[62:63], v9 offset:14848
    ds_read_b128 v[164:167], v12 offset:16384
    s_waitcnt lgkmcnt(11)
    v_mfma_f32_32x32x16_bf16 v[96:111], v[68:71], v[148:151], v[96:111]
    s_waitcnt lgkmcnt(8) vmcnt(8)
    s_barrier
    v_mfma_f32_32x32x16_bf16 v[80:95], v[72:75], v[152:155], v[80:95]
    s_setprio 3
    v_add_u32 v8, 131072, v6
    v_xor_b32 v9, 32, v8
    ds_read_b64_tr_b16 v[64:65], v8 offset:0
    ds_read_b64_tr_b16 v[66:67], v8 offset:512
    ds_read_b64_tr_b16 v[68:69], v9 offset:8192
    ds_read_b64_tr_b16 v[70:71], v9 offset:8704
    ds_read_b128 v[168:171], v13 offset:16384
    s_add_u32 m0, s75, 0
    s_waitcnt lgkmcnt(11)
    v_mfma_f32_32x32x16_bf16 v[96:111], v[76:79], v[152:155], v[96:111]
    buffer_load_dwordx4 v2, s[32:35], s79 offen lds
    ds_read_b64_tr_b16 v[72:73], v8 offset:2048
    ds_read_b64_tr_b16 v[74:75], v8 offset:2560
    ds_read_b128 v[172:175], v14 offset:16384
    s_add_u32 m0, s75, 8192
    s_waitcnt lgkmcnt(11)
    v_mfma_f32_32x32x16_bf16 v[80:95], v[56:59], v[156:159], v[80:95]
    s_setprio 2
    buffer_load_dwordx4 v3, s[36:39], s79 offen lds
    ds_read_b64_tr_b16 v[76:77], v9 offset:10240
    ds_read_b64_tr_b16 v[78:79], v9 offset:10752
    s_waitcnt lgkmcnt(11)
    v_mfma_f32_32x32x16_bf16 v[96:111], v[60:63], v[156:159], v[96:111]
    ds_read_b64_tr_b16 v[56:57], v8 offset:4096
    ds_read_b64_tr_b16 v[58:59], v8 offset:4608
    ds_read_b128 v[176:179], v11 offset:32768
    s_waitcnt lgkmcnt(11)
    v_mfma_f32_32x32x16_bf16 v[80:95], v[64:67], v[160:163], v[80:95]
    s_setprio 1
    ds_read_b64_tr_b16 v[60:61], v9 offset:12288
    ds_read_b64_tr_b16 v[62:63], v9 offset:12800
    s_waitcnt lgkmcnt(11)
    v_mfma_f32_32x32x16_bf16 v[96:111], v[68:71], v[160:163], v[96:111]
    ds_read_b64_tr_b16 v[64:65], v8 offset:6144
    ds_read_b64_tr_b16 v[66:67], v8 offset:6656
    ds_read_b128 v[180:183], v12 offset:32768
    s_waitcnt lgkmcnt(11)
    v_mfma_f32_32x32x16_bf16 v[80:95], v[72:75], v[164:167], v[80:95]
    s_setprio 0
    ds_read_b64_tr_b16 v[68:69], v9 offset:14336
    ds_read_b64_tr_b16 v[70:71], v9 offset:14848
    ds_read_b128 v[184:187], v13 offset:32768
    s_waitcnt lgkmcnt(11)
    v_mfma_f32_32x32x16_bf16 v[96:111], v[76:79], v[164:167], v[96:111]
    s_waitcnt lgkmcnt(9) vmcnt(6)
    s_barrier
    v_mfma_f32_32x32x16_bf16 v[80:95], v[56:59], v[168:171], v[80:95]
    s_setprio 3
    v_add_u32 v8, 147456, v6
    v_xor_b32 v9, 32, v8
    ds_read_b64_tr_b16 v[72:73], v8 offset:0
    ds_read_b64_tr_b16 v[74:75], v8 offset:512
    ds_read_b64_tr_b16 v[76:77], v9 offset:8192
    ds_read_b64_tr_b16 v[78:79], v9 offset:8704
    ds_read_b128 v[188:191], v14 offset:32768
    s_add_u32 m0, s75, 16384
    s_waitcnt lgkmcnt(11)
    v_mfma_f32_32x32x16_bf16 v[96:111], v[60:63], v[168:171], v[96:111]
    buffer_load_dwordx4 v2, s[32:35], s80 offen lds
    ds_read_b64_tr_b16 v[56:57], v8 offset:2048
    ds_read_b64_tr_b16 v[58:59], v8 offset:2560
    s_waitcnt lgkmcnt(11)
    v_mfma_f32_32x32x16_bf16 v[80:95], v[64:67], v[172:175], v[80:95]
    s_setprio 2
    ds_read_b64_tr_b16 v[60:61], v9 offset:10240
    ds_read_b64_tr_b16 v[62:63], v9 offset:10752
    ds_read_b128 v[192:195], v11 offset:49152
    s_add_u32 m0, s75, 24576
    s_waitcnt lgkmcnt(11)
    v_mfma_f32_32x32x16_bf16 v[96:111], v[68:71], v[172:175], v[96:111]
    buffer_load_dwordx4 v3, s[36:39], s80 offen lds
    ds_read_b64_tr_b16 v[64:65], v8 offset:4096
    ds_read_b64_tr_b16 v[66:67], v8 offset:4608
    ds_read_b128 v[196:199], v12 offset:49152
    s_waitcnt lgkmcnt(11)
    v_mfma_f32_32x32x16_bf16 v[80:95], v[72:75], v[176:179], v[80:95]
    s_setprio 1
    ds_read_b64_tr_b16 v[68:69], v9 offset:12288
    ds_read_b64_tr_b16 v[70:71], v9 offset:12800
    s_add_u32 m0, s75, 114688
    s_waitcnt lgkmcnt(11)
    v_mfma_f32_32x32x16_bf16 v[96:111], v[76:79], v[176:179], v[96:111]
    buffer_load_dwordx4 v2, s[32:35], s81 offen lds
    ds_read_b64_tr_b16 v[72:73], v8 offset:6144
    ds_read_b64_tr_b16 v[74:75], v8 offset:6656
    ds_read_b128 v[200:203], v13 offset:49152
    s_waitcnt lgkmcnt(11)
    v_mfma_f32_32x32x16_bf16 v[80:95], v[56:59], v[180:183], v[80:95]
    s_setprio 0
    ds_read_b64_tr_b16 v[76:77], v9 offset:14336
    ds_read_b64_tr_b16 v[78:79], v9 offset:14848
    s_waitcnt lgkmcnt(11)
    v_mfma_f32_32x32x16_bf16 v[96:111], v[60:63], v[180:183], v[96:111]
    s_waitcnt lgkmcnt(8) vmcnt(3)
    s_barrier
    v_mfma_f32_32x32x16_bf16 v[80:95], v[64:67], v[184:187], v[80:95]
    s_setprio 3
    v_add_u32 v8, 0, v6
    v_xor_b32 v9, 32, v8
    ds_read_b64_tr_b16 v[56:57], v8 offset:0
    ds_read_b64_tr_b16 v[58:59], v8 offset:512
    s_lshl_b32 s3, s2, 9
    s_add_u32 s3, s3, 128
    v_lshlrev_b32 v52, 20, v0
    v_mov_b32 v53, 1
    buffer_atomic_add v53, v52, s[60:63], s3 offen sc1
    ds_read_b64_tr_b16 v[60:61], v9 offset:8192
    ds_read_b64_tr_b16 v[62:63], v9 offset:8704
    ds_read_b128 v[204:207], v14 offset:49152
    v_add_u32 v11, 0x10000, v11
    v_add_u32 v12, 0x10000, v12
    v_add_u32 v13, 0x10000, v13
    v_add_u32 v14, 0x10000, v14
    ds_read_b128 v[208:211], v11 offset:0
    s_add_u32 m0, s75, 122880
    s_waitcnt lgkmcnt(11)
    v_mfma_f32_32x32x16_bf16 v[96:111], v[68:71], v[184:187], v[96:111]
    buffer_load_dwordx4 v3, s[36:39], s81 offen lds
    ds_read_b64_tr_b16 v[64:65], v8 offset:2048
    ds_read_b64_tr_b16 v[66:67], v8 offset:2560
    s_waitcnt lgkmcnt(11)
    v_mfma_f32_32x32x16_bf16 v[80:95], v[72:75], v[188:191], v[80:95]
    s_setprio 2
    ds_read_b64_tr_b16 v[68:69], v9 offset:10240
    ds_read_b64_tr_b16 v[70:71], v9 offset:10752
    ds_read_b128 v[212:215], v12 offset:0
    s_add_u32 m0, s75, 32768
    s_waitcnt lgkmcnt(11)
    v_mfma_f32_32x32x16_bf16 v[96:111], v[76:79], v[188:191], v[96:111]
    buffer_load_dwordx4 v2, s[32:35], s82 offen lds
    ds_read_b64_tr_b16 v[72:73], v8 offset:4096
    ds_read_b64_tr_b16 v[74:75], v8 offset:4608
    s_waitcnt lgkmcnt(11)
    v_mfma_f32_32x32x16_bf16 v[80:95], v[56:59], v[192:195], v[80:95]
    s_setprio 1
    ds_read_b64_tr_b16 v[76:77], v9 offset:12288
    ds_read_b64_tr_b16 v[78:79], v9 offset:12800
    ds_read_b128 v[216:219], v13 offset:0
    s_add_u32 m0, s75, 40960
    s_waitcnt lgkmcnt(12)
    v_mfma_f32_32x32x16_bf16 v[96:111], v[60:63], v[192:195], v[96:111]
    buffer_load_dwordx4 v3, s[36:39], s82 offen lds
    ds_read_b64_tr_b16 v[56:57], v8 offset:6144
    ds_read_b64_tr_b16 v[58:59], v8 offset:6656
    ds_read_b128 v[220:223], v14 offset:0
    s_waitcnt lgkmcnt(11)
    v_mfma_f32_32x32x16_bf16 v[80:95], v[64:67], v[196:199], v[80:95]
    s_setprio 0
    ds_read_b64_tr_b16 v[60:61], v9 offset:14336
    ds_read_b64_tr_b16 v[62:63], v9 offset:14848
    s_waitcnt lgkmcnt(11)
    v_mfma_f32_32x32x16_bf16 v[96:111], v[68:71], v[196:199], v[96:111]
    s_waitcnt lgkmcnt(2) vmcnt(5)
    s_barrier
    v_mfma_f32_32x32x16_bf16 v[80:95], v[72:75], v[200:203], v[80:95]
    s_setprio 3
    v_add_u32 v8, 16384, v6
    v_xor_b32 v9, 32, v8
    ds_read_b64_tr_b16 v[64:65], v8 offset:0
    ds_read_b64_tr_b16 v[66:67], v8 offset:512
    ds_read_b64_tr_b16 v[68:69], v9 offset:8192
    ds_read_b64_tr_b16 v[70:71], v9 offset:8704
    ds_read_b128 v[224:227], v11 offset:16384
    s_add_u32 m0, s75, 131072
    v_mfma_f32_32x32x16_bf16 v[96:111], v[76:79], v[200:203], v[96:111]
    buffer_load_dwordx4 v2, s[40:43], s76 offen lds
    ds_read_b64_tr_b16 v[72:73], v8 offset:2048
    ds_read_b64_tr_b16 v[74:75], v8 offset:2560
    ds_read_b128 v[228:231], v12 offset:16384
    v_mfma_f32_32x32x16_bf16 v[80:95], v[56:59], v[204:207], v[80:95]
    s_and_b32 s24, s72, 3
    s_and_b32 s26, s71, 3
    s_mul_i32 s26, s26, 2
    s_add_u32 s26, s26, s24
    s_cmp_ge_u32 s26, 7
    s_cselect_b32 s27, 7, 0
    s_sub_u32 s26, s26, s27
    s_lshl_b32 s26, s26, 7
    s_add_u32 s32, s18, s26
    s_addc_u32 s33, s19, 0
    s_setprio 2
    ds_read_b64_tr_b16 v[76:77], v9 offset:10240
    ds_read_b64_tr_b16 v[78:79], v9 offset:10752
    ds_read_b128 v[232:235], v13 offset:16384
    s_add_u32 m0, s75, 139264
    s_waitcnt lgkmcnt(11)
    v_mfma_f32_32x32x16_bf16 v[96:111], v[60:63], v[204:207], v[96:111]
    s_sub_u32 s34, 1605632, s26
    s_mov_b32 s35, 0x20000
    s_add_u32 s36, s10, s26
    s_addc_u32 s37, s11, 0
    s_sub_u32 s38, 401408, s26
    buffer_load_dwordx4 v3, s[44:47], s76 offen lds
    ds_read_b64_tr_b16 v[56:57], v8 offset:4096
    ds_read_b64_tr_b16 v[58:59], v8 offset:4608
    s_waitcnt lgkmcnt(11)
    v_mfma_f32_32x32x16_bf16 v[80:95], v[64:67], v[208:211], v[80:95]
    s_mov_b32 s39, 0x20000
    s_lshr_b32 s27, s72, 2
    s_lshl_b32 s73, s71, 1
    s_add_u32 s73, s73, s27
    s_setprio 1
    ds_read_b64_tr_b16 v[60:61], v9 offset:12288
    ds_read_b64_tr_b16 v[62:63], v9 offset:12800
    ds_read_b128 v[236:239], v14 offset:16384
    s_add_u32 m0, s75, 49152
    s_waitcnt lgkmcnt(12)
    v_mfma_f32_32x32x16_bf16 v[96:111], v[68:71], v[208:211], v[96:111]
    s_mul_i32 s27, s73, 57344
    s_add_u32 s26, s26, s27
    s_add_u32 s28, s4, s26
    s_addc_u32 s29, s5, 0
    s_sub_u32 s30, 1835008, s26
    buffer_load_dwordx4 v2, s[40:43], s77 offen lds
    ds_read_b64_tr_b16 v[64:65], v8 offset:6144
    ds_read_b64_tr_b16 v[66:67], v8 offset:6656
    s_waitcnt lgkmcnt(11)
    v_mfma_f32_32x32x16_bf16 v[80:95], v[72:75], v[212:215], v[80:95]
    s_mov_b32 s31, 0x20000
    s_add_u32 s64, s20, s26
    s_addc_u32 s65, s21, 0
    s_sub_u32 s66, 1835008, s26
    s_mov_b32 s67, 0x20000
    s_setprio 0
    ds_read_b64_tr_b16 v[68:69], v9 offset:14336
    ds_read_b64_tr_b16 v[70:71], v9 offset:14848
    ds_read_b128 v[240:243], v11 offset:32768
    s_waitcnt lgkmcnt(11)
    v_mfma_f32_32x32x16_bf16 v[96:111], v[76:79], v[212:215], v[96:111]
    s_waitcnt lgkmcnt(5) vmcnt(3)
    s_barrier
    v_mfma_f32_32x32x16_bf16 v[80:95], v[56:59], v[216:219], v[80:95]
    s_lshr_b32 s22, s68, 1
    s_and_b32 s26, s68, 1
    s_lshl_b32 s73, s73, 1
    s_add_u32 s73, s73, s26
    s_setprio 3
    v_add_u32 v8, 114688, v6
    v_xor_b32 v9, 32, v8
    ds_read_b64_tr_b16 v[72:73], v8 offset:0
    ds_read_b64_tr_b16 v[74:75], v8 offset:512
    ds_read_b64_tr_b16 v[76:77], v9 offset:8192
    ds_read_b64_tr_b16 v[78:79], v9 offset:8704
    ds_read_b128 v[244:247], v12 offset:32768
    s_add_u32 m0, s75, 57344
    v_mfma_f32_32x32x16_bf16 v[96:111], v[60:63], v[216:219], v[96:111]
    s_mul_i32 s73, s73, 147456
    s_lshl_b32 s23, s69, 12
    s_mul_i32 s26, s26, 28672
    buffer_load_dwordx4 v3, s[44:47], s77 offen lds
    ds_read_b64_tr_b16 v[56:57], v8 offset:2048
    ds_read_b64_tr_b16 v[58:59], v8 offset:2560
    ds_read_b128 v[248:251], v13 offset:32768
    s_waitcnt lgkmcnt(11)
    v_mfma_f32_32x32x16_bf16 v[80:95], v[64:67], v[220:223], v[80:95]
    v_bfe_u32 v30, v0, 3, 3
    v_and_b32 v31, 7, v0
    ds_read_b64_tr_b16 v[60:61], v9 offset:10240
    ds_read_b64_tr_b16 v[62:63], v9 offset:10752
    s_add_u32 m0, s75, 65536
    s_waitcnt lgkmcnt(11)
    v_mfma_f32_32x32x16_bf16 v[96:111], v[68:71], v[220:223], v[96:111]
    v_bfe_u32 v54, v0, 4, 1
    v_lshlrev_b32 v54, 2, v54
    buffer_load_dwordx4 v2, s[40:43], s78 offen lds
    ds_read_b64_tr_b16 v[64:65], v8 offset:4096
    ds_read_b64_tr_b16 v[66:67], v8 offset:4608
    ds_read_b128 v[252:255], v14 offset:32768
    s_waitcnt lgkmcnt(11)
    v_mfma_f32_32x32x16_bf16 v[80:95], v[72:75], v[224:227], v[80:95]
    v_xor_b32 v31, v31, v54
    v_mul_u32_u24 v30, 896, v30
    s_setprio 2
    ds_read_b64_tr_b16 v[68:69], v9 offset:12288
    ds_read_b64_tr_b16 v[70:71], v9 offset:12800
    s_waitcnt lgkmcnt(8)
    s_add_u32 m0, s75, 73728
    v_mfma_f32_32x32x16_bf16 v[96:111], v[76:79], v[224:227], v[96:111]
    v_lshl_add_u32 v30, v31, 4, v30
    v_add_u32 v54, s26, v30
    s_mul_i32 s14, s22, 192
    buffer_load_dwordx4 v3, s[44:47], s78 offen lds
    ds_read_b64_tr_b16 v[72:73], v8 offset:6144
    ds_read_b64_tr_b16 v[74:75], v8 offset:6656
    v_mfma_f32_32x32x16_bf16 v[80:95], v[56:59], v[228:231], v[80:95]
    s_add_u32 s14, s14, 256
    s_lshl_b32 s15, s22, 6
    s_mul_i32 s6, s14, 896
    s_lshl_b32 s14, s14, 6
    ds_read_b64_tr_b16 v[76:77], v9 offset:14336
    ds_read_b64_tr_b16 v[78:79], v9 offset:14848
    s_waitcnt lgkmcnt(7)
    s_add_u32 m0, s75, 147456
    v_mfma_f32_32x32x16_bf16 v[96:111], v[60:63], v[228:231], v[96:111]
    s_add_u32 s14, s14, s73
    s_mul_i32 s7, s15, 896
    s_lshl_b32 s15, s15, 6
    s_add_u32 s15, s15, s73
    buffer_load_dwordx4 v2, s[40:43], s79 offen lds
    v_add_u32 v8, 32768, v6
    v_xor_b32 v9, 32, v8
    ds_read_b64_tr_b16 v[56:57], v8 offset:0
    ds_read_b64_tr_b16 v[58:59], v8 offset:512
    v_mfma_f32_32x32x16_bf16 v[80:95], v[64:67], v[232:235], v[80:95]
    s_and_b32 s26, s22, 1
    s_mul_i32 s27, s26, 192
    s_add_u32 s27, s27, 384
    s_mul_i32 s8, s27, 896
    s_setprio 1
    ds_read_b64_tr_b16 v[60:61], v9 offset:8192
    ds_read_b64_tr_b16 v[62:63], v9 offset:8704
    s_waitcnt lgkmcnt(6)
    s_add_u32 m0, s75, 155648
    v_mfma_f32_32x32x16_bf16 v[96:111], v[68:71], v[232:235], v[96:111]
    s_lshl_b32 s16, s27, 6
    s_mul_i32 s27, s26, 50176
    s_lshl_b32 s26, s26, 12
    s_add_u32 s26, s26, 114688
    buffer_load_dwordx4 v3, s[44:47], s79 offen lds
    ds_read_b64_tr_b16 v[64:65], v8 offset:2048
    ds_read_b64_tr_b16 v[66:67], v8 offset:2560
    v_mfma_f32_32x32x16_bf16 v[80:95], v[72:75], v[236:239], v[80:95]
    s_mov_b32 s9, 344064
    s_movk_i32 s17, 24576
    s_cmp_eq_u32 s70, 0
    s_cselect_b32 s8, s27, s8
    s_cselect_b32 s16, s26, s16
    s_cselect_b32 s9, 100352, s9
    s_cselect_b32 s17, 8192, s17
    s_cselect_b64 s[36:37], s[36:37], s[32:33]
    s_cselect_b32 s38, s38, s34
    s_add_u32 s16, s16, s73
    s_lshr_b32 s93, s2, 6
    s_lshl_b32 s93, s93, 5
    s_and_b32 s3, s2, 31
    s_add_u32 s93, s93, s3
    v_xor_b32 v17, 128, v0
    s_mov_b32 s88, s18
    s_mov_b32 s89, s19
    s_mov_b32 s90, 1605632
    s_mov_b32 s91, 0x20000
    s_mul_i32 s3, s93, 12544
    v_add_u32 v16, 414, v0
    v_lshlrev_b32 v15, 7, v0
    v_lshrrev_b32 v16, 9, v16
    v_lshl_add_u32 v15, v16, 22, v15
    buffer_load_dword v24, v15, s[88:91], s3 offen
    s_mov_b32 s88, s10
    s_mov_b32 s89, s11
    s_mov_b32 s90, 401408
    s_mov_b32 s91, 0x20000
    s_mul_i32 s3, s93, 3200
    v_add_u32 v16, 487, v17
    v_lshlrev_b32 v15, 7, v17
    v_lshrrev_b32 v16, 9, v16
    v_lshl_add_u32 v15, v16, 22, v15
    buffer_load_dword v25, v15, s[88:91], s3 offen
    ds_read_b64_tr_b16 v[68:69], v9 offset:10240
    ds_read_b64_tr_b16 v[70:71], v9 offset:10752
    s_waitcnt lgkmcnt(6)
    s_add_u32 m0, s75, 81920
    v_mfma_f32_32x32x16_bf16 v[96:111], v[76:79], v[236:239], v[96:111]
    s_add_u32 s72, s24, s71
    s_and_b32 s73, s72, 1
    s_and_b32 s72, s72, 1
    buffer_load_dwordx4 v2, s[40:43], s80 offen lds
    ds_read_b64_tr_b16 v[72:73], v8 offset:4096
    ds_read_b64_tr_b16 v[74:75], v8 offset:4608
    v_mfma_f32_32x32x16_bf16 v[80:95], v[56:59], v[240:243], v[80:95]
    v_add_f32_dpp v44, v44, v44 quad_perm:[1,0,3,2] row_mask:0xf bank_mask:0xf
    v_add_f32_dpp v45, v45, v45 quad_perm:[1,0,3,2] row_mask:0xf bank_mask:0xf
    s_setprio 0
    ds_read_b64_tr_b16 v[76:77], v9 offset:12288
    ds_read_b64_tr_b16 v[78:79], v9 offset:12800
    s_waitcnt lgkmcnt(6)
    s_add_u32 m0, s75, 90112
    v_mfma_f32_32x32x16_bf16 v[96:111], v[60:63], v[240:243], v[96:111]
    v_add_f32_dpp v44, v44, v44 quad_perm:[2,3,0,1] row_mask:0xf bank_mask:0xf
    v_add_f32_dpp v45, v45, v45 quad_perm:[2,3,0,1] row_mask:0xf bank_mask:0xf
    buffer_load_dwordx4 v3, s[44:47], s80 offen lds
    ds_read_b64_tr_b16 v[56:57], v8 offset:6144
    ds_read_b64_tr_b16 v[58:59], v8 offset:6656
    v_mfma_f32_32x32x16_bf16 v[80:95], v[64:67], v[244:247], v[80:95]
    v_add_f32_dpp v44, v44, v44 row_half_mirror row_mask:0xf bank_mask:0xf
    v_add_f32_dpp v45, v45, v45 row_half_mirror row_mask:0xf bank_mask:0xf
    ds_read_b64_tr_b16 v[60:61], v9 offset:14336
    ds_read_b64_tr_b16 v[62:63], v9 offset:14848
    s_waitcnt lgkmcnt(6)
    v_mfma_f32_32x32x16_bf16 v[96:111], v[68:71], v[244:247], v[96:111]
    s_waitcnt vmcnt(10)
    s_barrier
    v_mfma_f32_32x32x16_bf16 v[80:95], v[72:75], v[248:251], v[80:95]
    v_mul_f32 v44, 0x3b124925, v44
    v_mul_f32 v45, 0x3b124925, v45
    s_setprio 3
    v_add_u32 v8, 131072, v6
    v_xor_b32 v9, 32, v8
    ds_read_b64_tr_b16 v[64:65], v8 offset:0
    ds_read_b64_tr_b16 v[66:67], v8 offset:512
    ds_read_b64_tr_b16 v[68:69], v9 offset:8192
    ds_read_b64_tr_b16 v[70:71], v9 offset:8704
    s_waitcnt lgkmcnt(6)
    s_add_u32 m0, s75, 0
    v_mfma_f32_32x32x16_bf16 v[96:111], v[76:79], v[248:251], v[96:111]
    v_fma_f32 v44, -v38, v38, v44
    v_fma_f32 v45, -v39, v39, v45
    buffer_load_dwordx4 v2, s[40:43], s81 offen lds
    ds_read_b64_tr_b16 v[72:73], v8 offset:2048
    ds_read_b64_tr_b16 v[74:75], v8 offset:2560
    v_mfma_f32_32x32x16_bf16 v[80:95], v[56:59], v[252:255], v[80:95]
    v_max_f32 v44, 0, v44
    v_max_f32 v45, 0, v45
    s_setprio 2
    ds_read_b64_tr_b16 v[76:77], v9 offset:10240
    ds_read_b64_tr_b16 v[78:79], v9 offset:10752
    s_waitcnt lgkmcnt(6)
    s_add_u32 m0, s75, 8192
    v_mfma_f32_32x32x16_bf16 v[96:111], v[60:63], v[252:255], v[96:111]
    v_cvt_pk_bf16_f32 v45, v44, v45
    v_lshlrev_b32 v44, 16, v45
    buffer_load_dwordx4 v3, s[44:47], s81 offen lds
    v_and_b32 v45, 0xffff0000, v45
    v_add_f32 v44, 0x3727c5ac, v44
    v_add_f32 v45, 0x3727c5ac, v45
    v_cvt_pk_bf16_f32 v45, v44, v45
    v_lshlrev_b32 v44, 16, v45
    v_and_b32 v45, 0xffff0000, v45
    v_sqrt_f32 v44, v44
    v_sqrt_f32 v45, v45
    s_nop 0
    v_cvt_pk_bf16_f32 v45, v44, v45
    v_lshlrev_b32 v44, 16, v45
    v_and_b32 v45, 0xffff0000, v45
    ds_write_b32 v46, v44
    v_xor_b32 v46, 256, v46
    ds_write_b32 v46, v45
    ds_read_b64_tr_b16 v[56:57], v8 offset:4096
    ds_read_b64_tr_b16 v[58:59], v8 offset:4608
    v_mfma_f32_32x32x16_bf16 v[112:127], v[64:67], v[144:147], 0
    v_and_b32 v11, 31, v0
    s_lshl_b32 s26, s69, 7
    s_add_u32 s26, s26, 110592
    v_lshlrev_b32 v11, 2, v11
    v_add_u32 v11, s26, v11
    s_setprio 1
    ds_read_b64_tr_b16 v[60:61], v9 offset:12288
    ds_read_b64_tr_b16 v[62:63], v9 offset:12800
    s_waitcnt lgkmcnt(8)
    s_add_u32 m0, s75, 16384
    v_mfma_f32_32x32x16_bf16 v[128:143], v[68:71], v[144:147], 0
    buffer_load_dwordx4 v2, s[40:43], s82 offen lds
    ds_read_b64_tr_b16 v[64:65], v8 offset:6144
    ds_read_b64_tr_b16 v[66:67], v8 offset:6656
    v_mfma_f32_32x32x16_bf16 v[112:127], v[72:75], v[148:151], v[112:127]
    s_setprio 0
    ds_read_b64_tr_b16 v[68:69], v9 offset:14336
    ds_read_b64_tr_b16 v[70:71], v9 offset:14848
    s_waitcnt lgkmcnt(6)
    v_mfma_f32_32x32x16_bf16 v[128:143], v[76:79], v[148:151], v[128:143]
    s_waitcnt vmcnt(9)
    s_barrier
    v_mfma_f32_32x32x16_bf16 v[112:127], v[56:59], v[152:155], v[112:127]
    ds_read_b32 v14, v11
    s_setprio 3
    v_add_u32 v8, 49152, v6
    v_xor_b32 v9, 32, v8
    ds_read_b64_tr_b16 v[72:73], v8 offset:0
    ds_read_b64_tr_b16 v[74:75], v8 offset:512
    ds_read_b64_tr_b16 v[76:77], v9 offset:8192
    ds_read_b64_tr_b16 v[78:79], v9 offset:8704
    s_waitcnt lgkmcnt(7)
    s_add_u32 m0, s75, 24576
    v_mfma_f32_32x32x16_bf16 v[128:143], v[60:63], v[152:155], v[128:143]
    buffer_load_dwordx4 v3, s[44:47], s82 offen lds
    ds_read_b64_tr_b16 v[56:57], v8 offset:2048
    ds_read_b64_tr_b16 v[58:59], v8 offset:2560
    v_mfma_f32_32x32x16_bf16 v[112:127], v[64:67], v[156:159], v[112:127]
    s_waitcnt lgkmcnt(6)
    v_rcp_f32 v13, v14
    v_mul_f32 v12, v14, v14
    v_mul_f32 v10, 0xc0135761, v13
    v_mul_f32 v11, v13, v13
    v_mul_f32 v11, 0x3d372713, v11
    ds_read_b64_tr_b16 v[60:61], v9 offset:10240
    ds_read_b64_tr_b16 v[62:63], v9 offset:10752
    s_waitcnt lgkmcnt(6)
    s_add_u32 m0, s75, 114688
    v_mfma_f32_32x32x16_bf16 v[128:143], v[68:71], v[156:159], v[128:143]
    v_mul_f32 v11, v10, v11
    v_mul_f32 v13, 0x3fb8aa3b, v13
    v_mul_f32 v26, v80, v80
    v_mul_f32 v27, v81, v81
    v_mul_f32 v28, v82, v82
    v_mul_f32 v29, v83, v83
    v_fma_f32 v26, v26, v11, v10
    buffer_load_dwordx4 v2, s[48:51], s76 offen lds
    ds_read_b64_tr_b16 v[64:65], v8 offset:4096
    ds_read_b64_tr_b16 v[66:67], v8 offset:4608
    v_mfma_f32_32x32x16_bf16 v[112:127], v[72:75], v[160:163], v[112:127]
    v_fma_f32 v27, v27, v11, v10
    v_fma_f32 v28, v28, v11, v10
    v_fma_f32 v29, v29, v11, v10
    v_mul_f32 v26, v80, v26
    v_mul_f32 v27, v81, v27
    v_mul_f32 v28, v82, v28
    s_setprio 2
    ds_read_b64_tr_b16 v[68:69], v9 offset:12288
    ds_read_b64_tr_b16 v[70:71], v9 offset:12800
    s_waitcnt lgkmcnt(6)
    v_mfma_f32_32x32x16_bf16 v[128:143], v[76:79], v[160:163], v[128:143]
    v_mul_f32 v29, v83, v29
    v_exp_f32 v26, v26
    v_mul_f32 v96, v80, v96
    v_exp_f32 v27, v27
    v_mul_f32 v97, v81, v97
    ds_read_b64_tr_b16 v[72:73], v8 offset:6144
    ds_read_b64_tr_b16 v[74:75], v8 offset:6656
    s_add_u32 m0, s75, 122880
    v_mfma_f32_32x32x16_bf16 v[112:127], v[56:59], v[164:167], v[112:127]
    v_exp_f32 v28, v28
    v_mul_f32 v98, v82, v98
    v_exp_f32 v29, v29
    v_mul_f32 v99, v83, v99
    buffer_load_dwordx4 v3, s[52:55], s76 offen lds
    v_lshlrev_b32 v52, 6, v0
    buffer_load_dword v53, v52, s[60:63], 0 offen offset:128 sc1
    v_cmp_eq_u32 vcc, 0, v0
    s_nop 1
    v_cndmask_b32 v52, 0, 1, vcc
    ds_read_b64_tr_b16 v[76:77], v9 offset:14336
    ds_read_b64_tr_b16 v[78:79], v9 offset:14848
    s_waitcnt lgkmcnt(6)
    v_mfma_f32_32x32x16_bf16 v[128:143], v[60:63], v[164:167], v[128:143]
    v_fma_f32 v26, v26, v12, v12
    v_fma_f32 v27, v27, v12, v12
    v_fma_f32 v28, v28, v12, v12
    v_fma_f32 v29, v29, v12, v12
    v_rcp_f32 v26, v26
    v_add_u32 v8, 65536, v6
    v_xor_b32 v9, 32, v8
    ds_read_b64_tr_b16 v[56:57], v8 offset:0
    ds_read_b64_tr_b16 v[58:59], v8 offset:512
    v_mfma_f32_32x32x16_bf16 v[112:127], v[64:67], v[168:171], v[112:127]
    v_rcp_f32 v27, v27
    v_rcp_f32 v28, v28
    v_rcp_f32 v29, v29
    v_mul_f32 v96, v96, v26
    s_setprio 1
    ds_read_b64_tr_b16 v[60:61], v9 offset:8192
    ds_read_b64_tr_b16 v[62:63], v9 offset:8704
    s_waitcnt lgkmcnt(6)
    s_add_u32 m0, s75, 32768
    v_mfma_f32_32x32x16_bf16 v[128:143], v[68:71], v[168:171], v[128:143]
    v_mul_f32 v97, v97, v27
    v_mul_f32 v98, v98, v28
    v_mul_f32 v99, v99, v29
    v_cvt_pk_bf16_f32 v32, v96, v97
    v_cvt_pk_bf16_f32 v33, v98, v99
    v_mul_f32 v26, v84, v84
    v_mul_f32 v27, v85, v85
    buffer_load_dwordx4 v2, s[48:51], s77 offen lds
    ds_read_b64_tr_b16 v[64:65], v8 offset:2048
    ds_read_b64_tr_b16 v[66:67], v8 offset:2560
    v_mfma_f32_32x32x16_bf16 v[112:127], v[72:75], v[172:175], v[112:127]
    v_mul_f32 v28, v86, v86
    v_mul_f32 v29, v87, v87
    v_fma_f32 v26, v26, v11, v10
    v_fma_f32 v27, v27, v11, v10
    v_fma_f32 v28, v28, v11, v10
    v_fma_f32 v29, v29, v11, v10
    ds_read_b64_tr_b16 v[68:69], v9 offset:10240
    ds_read_b64_tr_b16 v[70:71], v9 offset:10752
    s_waitcnt lgkmcnt(6)
    v_mfma_f32_32x32x16_bf16 v[128:143], v[76:79], v[172:175], v[128:143]
    v_mul_f32 v26, v84, v26
    v_mul_f32 v27, v85, v27
    v_mul_f32 v28, v86, v28
    v_mul_f32 v29, v87, v29
    v_exp_f32 v26, v26
    v_mul_f32 v100, v84, v100
    ds_read_b64_tr_b16 v[72:73], v8 offset:4096
    ds_read_b64_tr_b16 v[74:75], v8 offset:4608
    s_add_u32 m0, s75, 40960
    v_mfma_f32_32x32x16_bf16 v[112:127], v[56:59], v[176:179], v[112:127]
    v_exp_f32 v27, v27
    v_mul_f32 v101, v85, v101
    v_exp_f32 v28, v28
    v_mul_f32 v102, v86, v102
    s_setprio 0
    buffer_load_dwordx4 v3, s[52:55], s77 offen lds
    ds_read_b64_tr_b16 v[76:77], v9 offset:12288
    ds_read_b64_tr_b16 v[78:79], v9 offset:12800
    s_waitcnt lgkmcnt(6)
    v_mfma_f32_32x32x16_bf16 v[128:143], v[60:63], v[176:179], v[128:143]
    v_exp_f32 v29, v29
    v_mul_f32 v103, v87, v103
    v_fma_f32 v26, v26, v12, v12
    v_fma_f32 v27, v27, v12, v12
    v_fma_f32 v28, v28, v12, v12
    v_fma_f32 v29, v29, v12, v12
    ds_read_b64_tr_b16 v[56:57], v8 offset:6144
    ds_read_b64_tr_b16 v[58:59], v8 offset:6656
    v_mfma_f32_32x32x16_bf16 v[112:127], v[64:67], v[180:183], v[112:127]
    v_rcp_f32 v26, v26
    v_rcp_f32 v27, v27
    v_rcp_f32 v28, v28
    ds_read_b64_tr_b16 v[60:61], v9 offset:14336
    ds_read_b64_tr_b16 v[62:63], v9 offset:14848
    s_waitcnt lgkmcnt(6)
    v_mfma_f32_32x32x16_bf16 v[128:143], v[68:71], v[180:183], v[128:143]
    s_waitcnt vmcnt(2)
    v_cmp_gt_u32 vcc, v52, v53
    s_cbranch_vccnz R_CFF
B_CFF:
    s_barrier
    v_mfma_f32_32x32x16_bf16 v[112:127], v[72:75], v[184:187], v[112:127]
    v_rcp_f32 v29, v29
    v_mul_f32 v100, v100, v26
    v_mul_f32 v101, v101, v27
    v_mul_f32 v102, v102, v28
    v_mul_f32 v103, v103, v29
    v_cvt_pk_bf16_f32 v34, v100, v101
    s_setprio 3
    v_add_u32 v8, 147456, v6
    v_xor_b32 v9, 32, v8
    ds_read_b64_tr_b16 v[64:65], v8 offset:0
    ds_read_b64_tr_b16 v[66:67], v8 offset:512
    s_lshl_b32 s3, s71, 10
    s_add_u32 s3, s3, 12648448
    v_mov_b32 v52, s3
    v_mov_b32 v53, 0x7ff00000
    v_cmp_eq_u32 vcc, 0, v0
    s_nop 1
    v_cndmask_b32 v52, v53, v52, vcc
    v_cndmask_b32 v5, 0, 1, vcc
    ds_read_b64_tr_b16 v[68:69], v9 offset:8192
    ds_read_b64_tr_b16 v[70:71], v9 offset:8704
    s_waitcnt lgkmcnt(6)
    v_mfma_f32_32x32x16_bf16 v[128:143], v[76:79], v[184:187], v[128:143]
    v_cvt_pk_bf16_f32 v35, v102, v103
    buffer_store_dwordx4 v[32:35], v1, s[56:59], s97 offen sc0 sc1
    v_mul_f32 v26, v88, v88
    v_mul_f32 v27, v89, v89
    v_mul_f32 v28, v90, v90
    v_mul_f32 v29, v91, v91
    v_fma_f32 v26, v26, v11, v10
    s_mul_i32 s25, s70, -81920
    s_add_u32 s25, s25, s23
    s_mul_i32 s83, s72, 688128
    s_add_u32 s83, s83, s6
    s_add_u32 m0, s25, 131072
    s_add_u32 s3, s83, 0
    buffer_load_dwordx4 v54, s[32:35], s3 offen lds
    ds_read_b64_tr_b16 v[72:73], v8 offset:2048
    ds_read_b64_tr_b16 v[74:75], v8 offset:2560
    v_mfma_f32_32x32x16_bf16 v[112:127], v[56:59], v[188:191], v[112:127]
    v_fma_f32 v27, v27, v11, v10
    v_fma_f32 v28, v28, v11, v10
    v_fma_f32 v29, v29, v11, v10
    v_mul_f32 v26, v88, v26
    v_mul_f32 v27, v89, v27
    v_mul_f32 v28, v90, v28
    ds_read_b64_tr_b16 v[76:77], v9 offset:10240
    ds_read_b64_tr_b16 v[78:79], v9 offset:10752
    s_waitcnt lgkmcnt(6)
    v_mfma_f32_32x32x16_bf16 v[128:143], v[60:63], v[188:191], v[128:143]
    v_mul_f32 v29, v91, v29
    v_exp_f32 v26, v26
    v_mul_f32 v104, v88, v104
    v_exp_f32 v27, v27
    v_mul_f32 v105, v89, v105
    ds_read_b64_tr_b16 v[56:57], v8 offset:4096
    ds_read_b64_tr_b16 v[58:59], v8 offset:4608
    v_mfma_f32_32x32x16_bf16 v[112:127], v[64:67], v[192:195], v[112:127]
    v_exp_f32 v28, v28
    v_mul_f32 v106, v90, v106
    v_exp_f32 v29, v29
    v_mul_f32 v107, v91, v107
    s_setprio 2
    s_add_u32 m0, s25, 132096
    s_add_u32 s3, s83, 7168
    buffer_load_dwordx4 v54, s[32:35], s3 offen lds
    ds_read_b64_tr_b16 v[60:61], v9 offset:12288
    ds_read_b64_tr_b16 v[62:63], v9 offset:12800
    s_waitcnt lgkmcnt(6)
    v_mfma_f32_32x32x16_bf16 v[128:143], v[68:71], v[192:195], v[128:143]
    v_fma_f32 v26, v26, v12, v12
    v_fma_f32 v27, v27, v12, v12
    v_fma_f32 v28, v28, v12, v12
    v_fma_f32 v29, v29, v12, v12
    v_rcp_f32 v26, v26
    ds_read_b64_tr_b16 v[64:65], v8 offset:6144
    ds_read_b64_tr_b16 v[66:67], v8 offset:6656
    v_mfma_f32_32x32x16_bf16 v[112:127], v[72:75], v[196:199], v[112:127]
    v_rcp_f32 v27, v27
    v_rcp_f32 v28, v28
    v_rcp_f32 v29, v29
    v_mul_f32 v104, v104, v26
    ds_read_b64_tr_b16 v[68:69], v9 offset:14336
    ds_read_b64_tr_b16 v[70:71], v9 offset:14848
    s_waitcnt lgkmcnt(6)
    v_mfma_f32_32x32x16_bf16 v[128:143], v[76:79], v[196:199], v[128:143]
    v_mul_f32 v105, v105, v27
    v_mul_f32 v106, v106, v28
    v_mul_f32 v107, v107, v29
    v_cvt_pk_bf16_f32 v36, v104, v105
    v_cvt_pk_bf16_f32 v37, v106, v107
    v_mul_f32 v26, v92, v92
    v_mul_f32 v27, v93, v93
    s_add_u32 m0, s25, 133120
    s_add_u32 s3, s83, 14336
    buffer_load_dwordx4 v54, s[32:35], s3 offen lds
    v_add_u32 v8, 81920, v6
    v_xor_b32 v9, 32, v8
    ds_read_b64_tr_b16 v[72:73], v8 offset:0
    ds_read_b64_tr_b16 v[74:75], v8 offset:512
    v_mfma_f32_32x32x16_bf16 v[112:127], v[56:59], v[200:203], v[112:127]
    v_mul_f32 v28, v94, v94
    v_mul_f32 v29, v95, v95
    v_fma_f32 v26, v26, v11, v10
    v_fma_f32 v27, v27, v11, v10
    v_fma_f32 v28, v28, v11, v10
    v_fma_f32 v29, v29, v11, v10
    s_setprio 1
    ds_read_b64_tr_b16 v[76:77], v9 offset:8192
    ds_read_b64_tr_b16 v[78:79], v9 offset:8704
    s_waitcnt lgkmcnt(6)
    v_mfma_f32_32x32x16_bf16 v[128:143], v[60:63], v[200:203], v[128:143]
    v_mul_f32 v26, v92, v26
    v_mul_f32 v27, v93, v27
    v_mul_f32 v28, v94, v28
    v_mul_f32 v29, v95, v29
    v_exp_f32 v26, v26
    v_mul_f32 v108, v92, v108
    ds_read_b64_tr_b16 v[56:57], v8 offset:2048
    ds_read_b64_tr_b16 v[58:59], v8 offset:2560
    v_mfma_f32_32x32x16_bf16 v[112:127], v[64:67], v[204:207], v[112:127]
    v_exp_f32 v27, v27
    v_mul_f32 v109, v93, v109
    v_exp_f32 v28, v28
    v_mul_f32 v110, v94, v110
    ds_read_b64_tr_b16 v[60:61], v9 offset:10240
    ds_read_b64_tr_b16 v[62:63], v9 offset:10752
    s_waitcnt lgkmcnt(6)
    v_mfma_f32_32x32x16_bf16 v[128:143], v[68:71], v[204:207], v[128:143]
    v_exp_f32 v29, v29
    v_mul_f32 v111, v95, v111
    v_fma_f32 v26, v26, v12, v12
    v_fma_f32 v27, v27, v12, v12
    v_fma_f32 v28, v28, v12, v12
    v_fma_f32 v29, v29, v12, v12
    s_add_u32 m0, s25, 134144
    s_add_u32 s3, s83, 21504
    buffer_load_dwordx4 v54, s[32:35], s3 offen lds
    ds_read_b64_tr_b16 v[64:65], v8 offset:4096
    ds_read_b64_tr_b16 v[66:67], v8 offset:4608
    v_mfma_f32_32x32x16_bf16 v[112:127], v[72:75], v[208:211], v[112:127]
    v_rcp_f32 v26, v26
    v_rcp_f32 v27, v27
    v_rcp_f32 v28, v28
    s_setprio 0
    ds_read_b64_tr_b16 v[68:69], v9 offset:12288
    ds_read_b64_tr_b16 v[70:71], v9 offset:12800
    s_waitcnt lgkmcnt(6)
    v_mfma_f32_32x32x16_bf16 v[128:143], v[76:79], v[208:211], v[128:143]
    v_rcp_f32 v29, v29
    v_mul_f32 v108, v108, v26
    v_mul_f32 v109, v109, v27
    v_mul_f32 v110, v110, v28
    v_mul_f32 v111, v111, v29
    v_cvt_pk_bf16_f32 v38, v108, v109
    ds_read_b64_tr_b16 v[72:73], v8 offset:6144
    ds_read_b64_tr_b16 v[74:75], v8 offset:6656
    v_mfma_f32_32x32x16_bf16 v[112:127], v[56:59], v[212:215], v[112:127]
    v_cvt_pk_bf16_f32 v39, v110, v111
    buffer_store_dwordx4 v[36:39], v1, s[56:59], s97 offen offset:1024 sc0 sc1
    v_bfe_u32 v26, v0, 5, 1
    v_bfe_u32 v27, v0, 2, 2
    v_lshl_add_u32 v27, v26, 2, v27
    v_and_b32 v28, 3, v0
    v_lshlrev_b32 v28, 3, v28
    ds_read_b64_tr_b16 v[76:77], v9 offset:14336
    ds_read_b64_tr_b16 v[78:79], v9 offset:14848
    s_waitcnt lgkmcnt(6)
    v_mfma_f32_32x32x16_bf16 v[128:143], v[60:63], v[212:215], v[128:143]
    s_barrier
    v_mfma_f32_32x32x16_bf16 v[112:127], v[64:67], v[216:219], v[112:127]
    v_bfe_u32 v29, v0, 4, 1
    v_lshl_add_u32 v28, v29, 5, v28
    s_setprio 3
    v_add_u32 v8, 0, v6
    v_xor_b32 v9, 32, v8
    ds_read_b64_tr_b16 v[56:57], v8 offset:0
    ds_read_b64_tr_b16 v[58:59], v8 offset:512
    ds_read_b64_tr_b16 v[60:61], v9 offset:8192
    ds_read_b64_tr_b16 v[62:63], v9 offset:8704
    s_waitcnt lgkmcnt(6)
    s_add_u32 m0, s75, 98304
    v_mfma_f32_32x32x16_bf16 v[128:143], v[68:71], v[216:219], v[128:143]
    v_bfe_u32 v29, v0, 3, 1
    v_lshl_add_u32 v28, v29, 6, v28
    buffer_load_dwordx4 v2, s[48:51], s78 offen lds
    ds_read_b64_tr_b16 v[64:65], v8 offset:2048
    ds_read_b64_tr_b16 v[66:67], v8 offset:2560
    v_mfma_f32_32x32x16_bf16 v[112:127], v[72:75], v[220:223], v[112:127]
    v_lshl_add_u32 v27, v27, 7, v28
    s_and_b32 s26, s22, 1
    s_lshl_b32 s26, s26, 13
    s_setprio 2
    ds_read_b64_tr_b16 v[68:69], v9 offset:10240
    ds_read_b64_tr_b16 v[70:71], v9 offset:10752
    s_waitcnt lgkmcnt(6)
    s_add_u32 m0, s75, 106496
    v_mfma_f32_32x32x16_bf16 v[128:143], v[76:79], v[220:223], v[128:143]
    v_add_u32 v7, s26, v27
    v_and_b32 v27, 7, v0
    buffer_load_dwordx4 v3, s[52:55], s78 offen lds
    ds_read_b64_tr_b16 v[72:73], v8 offset:4096
    ds_read_b64_tr_b16 v[74:75], v8 offset:4608
    v_mfma_f32_32x32x16_bf16 v[112:127], v[56:59], v[224:227], v[112:127]
    v_xor_b32 v28, v26, v27
    v_and_b32 v29, 31, v0
    s_setprio 1
    ds_read_b64_tr_b16 v[76:77], v9 offset:12288
    ds_read_b64_tr_b16 v[78:79], v9 offset:12800
    s_waitcnt lgkmcnt(6)
    v_mfma_f32_32x32x16_bf16 v[128:143], v[60:63], v[224:227], v[128:143]
    v_bfe_u32 v26, v0, 6, 1
    v_lshl_add_u32 v29, v26, 5, v29
    s_mul_i32 s25, s70, 81920
    s_add_u32 s25, s25, s23
    s_mul_i32 s83, s72, -688128
    s_add_u32 s83, s83, s6
    s_add_u32 m0, s25, 65536
    s_add_u32 s3, s83, 688128
    buffer_load_dwordx4 v54, s[32:35], s3 offen lds
    ds_read_b64_tr_b16 v[56:57], v8 offset:6144
    ds_read_b64_tr_b16 v[58:59], v8 offset:6656
    v_mfma_f32_32x32x16_bf16 v[112:127], v[64:67], v[228:231], v[112:127]
    v_lshlrev_b32 v29, 8, v29
    v_lshl_add_u32 v20, v28, 4, v29
    s_setprio 0
    ds_read_b64_tr_b16 v[60:61], v9 offset:14336
    ds_read_b64_tr_b16 v[62:63], v9 offset:14848
    s_waitcnt lgkmcnt(6)
    v_mfma_f32_32x32x16_bf16 v[128:143], v[68:71], v[228:231], v[128:143]
    s_waitcnt vmcnt(3)
    s_barrier
    v_mfma_f32_32x32x16_bf16 v[112:127], v[72:75], v[232:235], v[112:127]
    v_lshrrev_b32 v26, 3, v0
    v_and_b32 v28, 7, v26
    s_setprio 3
    v_add_u32 v8, 16384, v6
    v_xor_b32 v9, 32, v8
    ds_read_b64_tr_b16 v[64:65], v8 offset:0
    ds_read_b64_tr_b16 v[66:67], v8 offset:512
    buffer_atomic_add v5, v52, s[56:59], 0 offen offset:0 sc1
    ds_read_b64_tr_b16 v[68:69], v9 offset:8192
    ds_read_b64_tr_b16 v[70:71], v9 offset:8704
    s_waitcnt lgkmcnt(6)
    s_add_u32 m0, s75, 81920
    v_mfma_f32_32x32x16_bf16 v[128:143], v[76:79], v[232:235], v[128:143]
    v_lshlrev_b32 v29, 1, v27
    v_xor_b32 v29, v29, v28
    buffer_load_dwordx4 v2, s[48:51], s79 offen lds
    ds_read_b64_tr_b16 v[72:73], v8 offset:2048
    ds_read_b64_tr_b16 v[74:75], v8 offset:2560
    v_mfma_f32_32x32x16_bf16 v[112:127], v[56:59], v[236:239], v[112:127]
    v_lshlrev_b32 v29, 4, v29
    v_lshl_add_u32 v19, v26, 8, v29
    ds_read_b64_tr_b16 v[76:77], v9 offset:10240
    ds_read_b64_tr_b16 v[78:79], v9 offset:10752
    s_waitcnt lgkmcnt(6)
    s_add_u32 m0, s75, 90112
    v_mfma_f32_32x32x16_bf16 v[128:143], v[60:63], v[236:239], v[128:143]
    v_mul_u32_u24 v21, 896, v26
    v_lshl_add_u32 v21, v27, 4, v21
    buffer_load_dwordx4 v3, s[52:55], s79 offen lds
    ds_read_b64_tr_b16 v[56:57], v8 offset:4096
    ds_read_b64_tr_b16 v[58:59], v8 offset:4608
    v_mfma_f32_32x32x16_bf16 v[112:127], v[64:67], v[240:243], v[112:127]
    s_and_b32 s26, s68, 5
    s_cmp_eq_u32 s26, 1
    s_cselect_b32 s26, 3584, 0
    v_subrev_u32 v4, s26, v54
    s_setprio 2
    ds_read_b64_tr_b16 v[60:61], v9 offset:12288
    ds_read_b64_tr_b16 v[62:63], v9 offset:12800
    s_waitcnt lgkmcnt(6)
    v_mfma_f32_32x32x16_bf16 v[128:143], v[68:71], v[240:243], v[128:143]
    ds_read_b64_tr_b16 v[64:65], v8 offset:6144
    ds_read_b64_tr_b16 v[66:67], v8 offset:6656
    v_mfma_f32_32x32x16_bf16 v[112:127], v[72:75], v[244:247], v[112:127]
    s_add_u32 m0, s25, 66560
    s_add_u32 s3, s83, 695296
    buffer_load_dwordx4 v54, s[32:35], s3 offen lds
    ds_read_b64_tr_b16 v[68:69], v9 offset:14336
    ds_read_b64_tr_b16 v[70:71], v9 offset:14848
    s_waitcnt lgkmcnt(6)
    v_mfma_f32_32x32x16_bf16 v[128:143], v[76:79], v[244:247], v[128:143]
    v_add_u32 v8, 114688, v6
    v_xor_b32 v9, 32, v8
    ds_read_b64_tr_b16 v[72:73], v8 offset:0
    ds_read_b64_tr_b16 v[74:75], v8 offset:512
    v_mfma_f32_32x32x16_bf16 v[112:127], v[56:59], v[248:251], v[112:127]
    s_setprio 1
    ds_read_b64_tr_b16 v[76:77], v9 offset:8192
    ds_read_b64_tr_b16 v[78:79], v9 offset:8704
    s_waitcnt lgkmcnt(6)
    v_mfma_f32_32x32x16_bf16 v[128:143], v[60:63], v[248:251], v[128:143]
    s_add_u32 m0, s25, 67584
    s_add_u32 s3, s83, 702464
    buffer_load_dwordx4 v54, s[32:35], s3 offen lds
    ds_read_b64_tr_b16 v[56:57], v8 offset:2048
    ds_read_b64_tr_b16 v[58:59], v8 offset:2560
    v_mfma_f32_32x32x16_bf16 v[112:127], v[64:67], v[252:255], v[112:127]
    ds_read_b64_tr_b16 v[60:61], v9 offset:10240
    ds_read_b64_tr_b16 v[62:63], v9 offset:10752
    s_waitcnt lgkmcnt(6)
    v_mfma_f32_32x32x16_bf16 v[128:143], v[68:71], v[252:255], v[128:143]
    ds_read_b64_tr_b16 v[64:65], v8 offset:4096
    ds_read_b64_tr_b16 v[66:67], v8 offset:4608
    v_mfma_f32_32x32x16_bf16 v[80:95], v[72:75], v[144:147], 0
    s_setprio 0
    s_add_u32 m0, s25, 68608
    s_add_u32 s3, s83, 709632
    buffer_load_dwordx4 v54, s[32:35], s3 offen lds
    ds_read_b64_tr_b16 v[68:69], v9 offset:12288
    ds_read_b64_tr_b16 v[70:71], v9 offset:12800
    s_waitcnt lgkmcnt(6)
    v_mfma_f32_32x32x16_bf16 v[96:111], v[76:79], v[144:147], 0
    ds_read_b64_tr_b16 v[72:73], v8 offset:6144
    ds_read_b64_tr_b16 v[74:75], v8 offset:6656
    v_mfma_f32_32x32x16_bf16 v[80:95], v[56:59], v[148:151], v[80:95]
    ds_read_b64_tr_b16 v[76:77], v9 offset:14336
    ds_read_b64_tr_b16 v[78:79], v9 offset:14848
    s_waitcnt lgkmcnt(6)
    v_mfma_f32_32x32x16_bf16 v[96:111], v[60:63], v[148:151], v[96:111]
    s_waitcnt vmcnt(7)
    s_barrier
    v_mfma_f32_32x32x16_bf16 v[80:95], v[64:67], v[152:155], v[80:95]
    v_mul_f32 v26, v112, v112
    v_mul_f32 v27, v113, v113
    v_mul_f32 v28, v114, v114
    v_mul_f32 v29, v115, v115
    v_fma_f32 v26, v26, v11, v10
    s_setprio 3
    v_add_u32 v8, 32768, v6
    v_xor_b32 v9, 32, v8
    ds_read_b64_tr_b16 v[56:57], v8 offset:0
    ds_read_b64_tr_b16 v[58:59], v8 offset:512
    ds_read_b64_tr_b16 v[60:61], v9 offset:8192
    ds_read_b64_tr_b16 v[62:63], v9 offset:8704
    s_waitcnt lgkmcnt(6)
    s_add_u32 m0, s75, 0
    v_mfma_f32_32x32x16_bf16 v[96:111], v[68:71], v[152:155], v[96:111]
    v_fma_f32 v27, v27, v11, v10
    v_fma_f32 v28, v28, v11, v10
    v_fma_f32 v29, v29, v11, v10
    v_mul_f32 v26, v112, v26
    v_mul_f32 v27, v113, v27
    buffer_load_dwordx4 v2, s[48:51], s80 offen lds
    ds_read_b64_tr_b16 v[64:65], v8 offset:2048
    ds_read_b64_tr_b16 v[66:67], v8 offset:2560
    v_mfma_f32_32x32x16_bf16 v[80:95], v[72:75], v[156:159], v[80:95]
    v_mul_f32 v28, v114, v28
    v_mul_f32 v29, v115, v29
    v_exp_f32 v26, v26
    v_mul_f32 v128, v112, v128
    ds_read_b64_tr_b16 v[68:69], v9 offset:10240
    ds_read_b64_tr_b16 v[70:71], v9 offset:10752
    s_waitcnt lgkmcnt(6)
    v_mfma_f32_32x32x16_bf16 v[96:111], v[76:79], v[156:159], v[96:111]
    v_exp_f32 v27, v27
    v_mul_f32 v129, v113, v129
    v_exp_f32 v28, v28
    ds_read_b64_tr_b16 v[72:73], v8 offset:4096
    ds_read_b64_tr_b16 v[74:75], v8 offset:4608
    s_add_u32 m0, s75, 8192
    v_mfma_f32_32x32x16_bf16 v[80:95], v[56:59], v[160:163], v[80:95]
    v_mul_f32 v130, v114, v130
    v_exp_f32 v29, v29
    v_mul_f32 v131, v115, v131
    v_fma_f32 v26, v26, v12, v12
    s_setprio 2
    buffer_load_dwordx4 v3, s[52:55], s80 offen lds
    buffer_load_dword v53, v52, s[56:59], 0 offen offset:0 sc1
    ds_read_b64_tr_b16 v[76:77], v9 offset:12288
    ds_read_b64_tr_b16 v[78:79], v9 offset:12800
    s_waitcnt lgkmcnt(6)
    v_mfma_f32_32x32x16_bf16 v[96:111], v[60:63], v[160:163], v[96:111]
    v_fma_f32 v27, v27, v12, v12
    v_fma_f32 v28, v28, v12, v12
    v_fma_f32 v29, v29, v12, v12
    v_rcp_f32 v26, v26
    ds_read_b64_tr_b16 v[56:57], v8 offset:6144
    ds_read_b64_tr_b16 v[58:59], v8 offset:6656
    v_mfma_f32_32x32x16_bf16 v[80:95], v[64:67], v[164:167], v[80:95]
    v_rcp_f32 v27, v27
    v_rcp_f32 v28, v28
    ds_read_b64_tr_b16 v[60:61], v9 offset:14336
    ds_read_b64_tr_b16 v[62:63], v9 offset:14848
    s_waitcnt lgkmcnt(6)
    s_add_u32 m0, s75, 16384
    v_mfma_f32_32x32x16_bf16 v[96:111], v[68:71], v[164:167], v[96:111]
    v_rcp_f32 v29, v29
    v_mul_f32 v128, v128, v26
    v_mul_f32 v129, v129, v27
    v_mul_f32 v130, v130, v28
    v_mul_f32 v131, v131, v29
    buffer_load_dwordx4 v2, s[48:51], s81 offen lds
    v_add_u32 v8, 98304, v6
    v_xor_b32 v9, 32, v8
    ds_read_b64_tr_b16 v[64:65], v8 offset:0
    ds_read_b64_tr_b16 v[66:67], v8 offset:512
    v_mfma_f32_32x32x16_bf16 v[80:95], v[72:75], v[168:171], v[80:95]
    v_cvt_pk_bf16_f32 v32, v128, v129
    v_cvt_pk_bf16_f32 v33, v130, v131
    v_mul_f32 v26, v116, v116
    v_mul_f32 v27, v117, v117
    v_mul_f32 v28, v118, v118
    s_setprio 1
    ds_read_b64_tr_b16 v[68:69], v9 offset:8192
    ds_read_b64_tr_b16 v[70:71], v9 offset:8704
    s_waitcnt lgkmcnt(6)
    v_mfma_f32_32x32x16_bf16 v[96:111], v[76:79], v[168:171], v[96:111]
    v_mul_f32 v29, v119, v119
    v_fma_f32 v26, v26, v11, v10
    v_fma_f32 v27, v27, v11, v10
    v_fma_f32 v28, v28, v11, v10
    v_fma_f32 v29, v29, v11, v10
    ds_read_b64_tr_b16 v[72:73], v8 offset:2048
    ds_read_b64_tr_b16 v[74:75], v8 offset:2560
    v_mfma_f32_32x32x16_bf16 v[80:95], v[56:59], v[172:175], v[80:95]
    v_mul_f32 v26, v116, v26
    v_mul_f32 v27, v117, v27
    v_mul_f32 v28, v118, v28
    v_mul_f32 v29, v119, v29
    ds_read_b64_tr_b16 v[76:77], v9 offset:10240
    ds_read_b64_tr_b16 v[78:79], v9 offset:10752
    s_waitcnt lgkmcnt(6)
    s_add_u32 m0, s75, 24576
    v_mfma_f32_32x32x16_bf16 v[96:111], v[60:63], v[172:175], v[96:111]
    v_exp_f32 v26, v26
    v_mul_f32 v132, v116, v132
    v_exp_f32 v27, v27
    v_mul_f32 v133, v117, v133
    buffer_load_dwordx4 v3, s[52:55], s81 offen lds
    ds_read_b64_tr_b16 v[56:57], v8 offset:4096
    ds_read_b64_tr_b16 v[58:59], v8 offset:4608
    v_mfma_f32_32x32x16_bf16 v[80:95], v[64:67], v[176:179], v[80:95]
    v_exp_f32 v28, v28
    v_mul_f32 v134, v118, v134
    v_exp_f32 v29, v29
    s_setprio 0
    ds_read_b64_tr_b16 v[60:61], v9 offset:12288
    ds_read_b64_tr_b16 v[62:63], v9 offset:12800
    s_waitcnt lgkmcnt(6)
    v_mfma_f32_32x32x16_bf16 v[96:111], v[68:71], v[176:179], v[96:111]
    v_mul_f32 v135, v119, v135
    v_fma_f32 v26, v26, v12, v12
    v_fma_f32 v27, v27, v12, v12
    v_fma_f32 v28, v28, v12, v12
    v_fma_f32 v29, v29, v12, v12
    ds_read_b64_tr_b16 v[64:65], v8 offset:6144
    ds_read_b64_tr_b16 v[66:67], v8 offset:6656
    v_mfma_f32_32x32x16_bf16 v[80:95], v[72:75], v[180:183], v[80:95]
    v_rcp_f32 v26, v26
    v_rcp_f32 v27, v27
    ds_read_b64_tr_b16 v[68:69], v9 offset:14336
    ds_read_b64_tr_b16 v[70:71], v9 offset:14848
    s_waitcnt lgkmcnt(6)
    v_mfma_f32_32x32x16_bf16 v[96:111], v[76:79], v[180:183], v[96:111]
    s_waitcnt vmcnt(2)
    v_lshrrev_b32 v53, 3, v53
    v_cmp_gt_u32 vcc, v5, v53
    s_cbranch_vccnz R_P0F
B_P0F:
    s_barrier
    v_mfma_f32_32x32x16_bf16 v[80:95], v[56:59], v[184:187], v[80:95]
    v_rcp_f32 v28, v28
    v_rcp_f32 v29, v29
    v_mul_f32 v132, v132, v26
    v_mul_f32 v133, v133, v27
    s_setprio 3
    v_add_u32 v8, 81920, v6
    v_xor_b32 v9, 32, v8
    ds_read_b64_tr_b16 v[72:73], v8 offset:0
    ds_read_b64_tr_b16 v[74:75], v8 offset:512
    ds_read_b64_tr_b16 v[76:77], v9 offset:8192
    ds_read_b64_tr_b16 v[78:79], v9 offset:8704
    s_waitcnt lgkmcnt(6)
    s_add_u32 m0, s75, 114688
    v_mfma_f32_32x32x16_bf16 v[96:111], v[60:63], v[184:187], v[96:111]
    v_mul_f32 v134, v134, v28
    v_mul_f32 v135, v135, v29
    v_cvt_pk_bf16_f32 v34, v132, v133
    v_cvt_pk_bf16_f32 v35, v134, v135
    buffer_store_dwordx4 v[32:35], v1, s[56:59], s98 offen sc0 sc1
    buffer_load_dwordx4 v2, s[48:51], s82 offen lds
    ds_read_b64_tr_b16 v[56:57], v8 offset:2048
    ds_read_b64_tr_b16 v[58:59], v8 offset:2560
    v_mfma_f32_32x32x16_bf16 v[80:95], v[64:67], v[188:191], v[80:95]
    v_mul_f32 v26, v120, v120
    v_mul_f32 v27, v121, v121
    v_mul_f32 v28, v122, v122
    v_mul_f32 v29, v123, v123
    v_fma_f32 v26, v26, v11, v10
    ds_read_b64_tr_b16 v[60:61], v9 offset:10240
    ds_read_b64_tr_b16 v[62:63], v9 offset:10752
    s_waitcnt lgkmcnt(6)
    s_add_u32 m0, s75, 122880
    v_mfma_f32_32x32x16_bf16 v[96:111], v[68:71], v[188:191], v[96:111]
    v_fma_f32 v27, v27, v11, v10
    v_fma_f32 v28, v28, v11, v10
    v_fma_f32 v29, v29, v11, v10
    v_mul_f32 v26, v120, v26
    v_mul_f32 v27, v121, v27
    buffer_load_dwordx4 v3, s[52:55], s82 offen lds
    ds_read_b64_tr_b16 v[64:65], v8 offset:4096
    ds_read_b64_tr_b16 v[66:67], v8 offset:4608
    v_mfma_f32_32x32x16_bf16 v[80:95], v[72:75], v[192:195], v[80:95]
    v_mul_f32 v28, v122, v28
    v_mul_f32 v29, v123, v29
    v_exp_f32 v26, v26
    v_mul_f32 v136, v120, v136
    s_setprio 2
    ds_read_b64_tr_b16 v[68:69], v9 offset:12288
    ds_read_b64_tr_b16 v[70:71], v9 offset:12800
    s_waitcnt lgkmcnt(6)
    v_mfma_f32_32x32x16_bf16 v[96:111], v[76:79], v[192:195], v[96:111]
    v_exp_f32 v27, v27
    v_mul_f32 v137, v121, v137
    v_exp_f32 v28, v28
    s_mul_i32 s84, s72, 49152
    s_add_u32 s84, s84, s14
    buffer_load_dwordx4 v[144:147], v1, s[56:59], s84 offen offset:0 sc1
    ds_read_b64_tr_b16 v[72:73], v8 offset:6144
    ds_read_b64_tr_b16 v[74:75], v8 offset:6656
    v_mfma_f32_32x32x16_bf16 v[80:95], v[56:59], v[196:199], v[80:95]
    v_mul_f32 v138, v122, v138
    v_exp_f32 v29, v29
    v_mul_f32 v139, v123, v139
    v_fma_f32 v26, v26, v12, v12
    ds_read_b64_tr_b16 v[76:77], v9 offset:14336
    ds_read_b64_tr_b16 v[78:79], v9 offset:14848
    s_waitcnt lgkmcnt(6)
    v_mfma_f32_32x32x16_bf16 v[96:111], v[60:63], v[196:199], v[96:111]
    v_fma_f32 v27, v27, v12, v12
    v_fma_f32 v28, v28, v12, v12
    v_fma_f32 v29, v29, v12, v12
    v_rcp_f32 v26, v26
    buffer_load_dwordx4 v[148:151], v1, s[56:59], s84 offen offset:1024 sc1
    v_add_u32 v8, 0, v6
    v_xor_b32 v9, 32, v8
    ds_read_b64_tr_b16 v[56:57], v8 offset:0
    ds_read_b64_tr_b16 v[58:59], v8 offset:512
    v_mfma_f32_32x32x16_bf16 v[80:95], v[64:67], v[200:203], v[80:95]
    v_rcp_f32 v27, v27
    v_rcp_f32 v28, v28
    s_setprio 1
    ds_read_b64_tr_b16 v[60:61], v9 offset:8192
    ds_read_b64_tr_b16 v[62:63], v9 offset:8704
    s_waitcnt lgkmcnt(6)
    v_mfma_f32_32x32x16_bf16 v[96:111], v[68:71], v[200:203], v[96:111]
    v_rcp_f32 v29, v29
    v_mul_f32 v136, v136, v26
    v_mul_f32 v137, v137, v27
    v_mul_f32 v138, v138, v28
    v_mul_f32 v139, v139, v29
    buffer_load_dwordx4 v[152:155], v1, s[56:59], s84 offen offset:2048 sc1
    ds_read_b64_tr_b16 v[64:65], v8 offset:2048
    ds_read_b64_tr_b16 v[66:67], v8 offset:2560
    v_mfma_f32_32x32x16_bf16 v[80:95], v[72:75], v[204:207], v[80:95]
    v_cvt_pk_bf16_f32 v36, v136, v137
    v_cvt_pk_bf16_f32 v37, v138, v139
    v_mul_f32 v26, v124, v124
    v_mul_f32 v27, v125, v125
    v_mul_f32 v28, v126, v126
    ds_read_b64_tr_b16 v[68:69], v9 offset:10240
    ds_read_b64_tr_b16 v[70:71], v9 offset:10752
    s_waitcnt lgkmcnt(6)
    v_mfma_f32_32x32x16_bf16 v[96:111], v[76:79], v[204:207], v[96:111]
    v_mul_f32 v29, v127, v127
    v_fma_f32 v26, v26, v11, v10
    v_fma_f32 v27, v27, v11, v10
    v_fma_f32 v28, v28, v11, v10
    v_fma_f32 v29, v29, v11, v10
    buffer_load_dwordx4 v[156:159], v1, s[56:59], s84 offen offset:3072 sc1
    ds_read_b64_tr_b16 v[72:73], v8 offset:4096
    ds_read_b64_tr_b16 v[74:75], v8 offset:4608
    v_mfma_f32_32x32x16_bf16 v[80:95], v[56:59], v[208:211], v[80:95]
    v_mul_f32 v26, v124, v26
    v_mul_f32 v27, v125, v27
    v_mul_f32 v28, v126, v28
    v_mul_f32 v29, v127, v29
    s_setprio 0
    ds_read_b64_tr_b16 v[76:77], v9 offset:12288
    ds_read_b64_tr_b16 v[78:79], v9 offset:12800
    s_waitcnt lgkmcnt(6)
    v_mfma_f32_32x32x16_bf16 v[96:111], v[60:63], v[208:211], v[96:111]
    v_exp_f32 v26, v26
    v_mul_f32 v140, v124, v140
    v_exp_f32 v27, v27
    v_mul_f32 v141, v125, v141
    s_mul_i32 s84, s72, -49152
    s_add_u32 s84, s84, s14
    s_add_u32 s84, s84, 49152
    buffer_load_dwordx4 v[160:163], v1, s[56:59], s84 offen offset:0 sc1
    ds_read_b64_tr_b16 v[56:57], v8 offset:6144
    ds_read_b64_tr_b16 v[58:59], v8 offset:6656
    v_mfma_f32_32x32x16_bf16 v[80:95], v[64:67], v[212:215], v[80:95]
    v_exp_f32 v28, v28
    v_mul_f32 v142, v126, v142
    v_exp_f32 v29, v29
    ds_read_b64_tr_b16 v[60:61], v9 offset:14336
    ds_read_b64_tr_b16 v[62:63], v9 offset:14848
    s_waitcnt lgkmcnt(6)
    v_mfma_f32_32x32x16_bf16 v[96:111], v[68:71], v[212:215], v[96:111]
    s_waitcnt vmcnt(8)
    s_barrier
    v_mfma_f32_32x32x16_bf16 v[80:95], v[72:75], v[216:219], v[80:95]
    v_mul_f32 v143, v127, v143
    v_fma_f32 v26, v26, v12, v12
    v_fma_f32 v27, v27, v12, v12
    v_fma_f32 v28, v28, v12, v12
    v_fma_f32 v29, v29, v12, v12
    s_setprio 3
    v_add_u32 v8, 16384, v6
    v_xor_b32 v9, 32, v8
    ds_read_b64_tr_b16 v[64:65], v8 offset:0
    ds_read_b64_tr_b16 v[66:67], v8 offset:512
    ds_read_b64_tr_b16 v[68:69], v9 offset:8192
    ds_read_b64_tr_b16 v[70:71], v9 offset:8704
    s_waitcnt lgkmcnt(6)
    v_mfma_f32_32x32x16_bf16 v[96:111], v[76:79], v[216:219], v[96:111]
    v_rcp_f32 v26, v26
    v_rcp_f32 v27, v27
    buffer_load_dwordx4 v[164:167], v1, s[56:59], s84 offen offset:1024 sc1
    ds_read_b64_tr_b16 v[72:73], v8 offset:2048
    ds_read_b64_tr_b16 v[74:75], v8 offset:2560
    v_mfma_f32_32x32x16_bf16 v[80:95], v[56:59], v[220:223], v[80:95]
    v_rcp_f32 v28, v28
    v_rcp_f32 v29, v29
    v_mul_f32 v140, v140, v26
    v_mul_f32 v141, v141, v27
    s_setprio 2
    ds_read_b64_tr_b16 v[76:77], v9 offset:10240
    ds_read_b64_tr_b16 v[78:79], v9 offset:10752
    s_waitcnt lgkmcnt(6)
    v_mfma_f32_32x32x16_bf16 v[96:111], v[60:63], v[220:223], v[96:111]
    v_mul_f32 v142, v142, v28
    v_mul_f32 v143, v143, v29
    v_cvt_pk_bf16_f32 v38, v140, v141
    v_cvt_pk_bf16_f32 v39, v142, v143
    buffer_store_dwordx4 v[36:39], v1, s[56:59], s98 offen offset:1024 sc0 sc1
    buffer_load_dwordx4 v[168:171], v1, s[56:59], s84 offen offset:2048 sc1
    ds_read_b64_tr_b16 v[56:57], v8 offset:4096
    ds_read_b64_tr_b16 v[58:59], v8 offset:4608
    v_mfma_f32_32x32x16_bf16 v[80:95], v[64:67], v[224:227], v[80:95]
    s_setprio 1
    ds_read_b64_tr_b16 v[60:61], v9 offset:12288
    ds_read_b64_tr_b16 v[62:63], v9 offset:12800
    s_waitcnt lgkmcnt(6)
    v_mfma_f32_32x32x16_bf16 v[96:111], v[68:71], v[224:227], v[96:111]
    buffer_load_dwordx4 v[172:175], v1, s[56:59], s84 offen offset:3072 sc1
    ds_read_b64_tr_b16 v[64:65], v8 offset:6144
    ds_read_b64_tr_b16 v[66:67], v8 offset:6656
    v_mfma_f32_32x32x16_bf16 v[80:95], v[72:75], v[228:231], v[80:95]
    s_setprio 0
    ds_read_b64_tr_b16 v[68:69], v9 offset:14336
    ds_read_b64_tr_b16 v[70:71], v9 offset:14848
    s_waitcnt lgkmcnt(6)
    v_mfma_f32_32x32x16_bf16 v[96:111], v[76:79], v[228:231], v[96:111]
    s_waitcnt vmcnt(9)
    s_barrier
    v_mfma_f32_32x32x16_bf16 v[80:95], v[56:59], v[232:235], v[80:95]
    s_setprio 3
    v_add_u32 v8, 114688, v6
    v_xor_b32 v9, 32, v8
    ds_read_b64_tr_b16 v[72:73], v8 offset:0
    ds_read_b64_tr_b16 v[74:75], v8 offset:512
    ds_read_b64_tr_b16 v[76:77], v9 offset:8192
    ds_read_b64_tr_b16 v[78:79], v9 offset:8704
    s_waitcnt lgkmcnt(6)
    v_mfma_f32_32x32x16_bf16 v[96:111], v[60:63], v[232:235], v[96:111]
    s_mul_i32 s25, s70, 65536
    s_add_u32 s25, s25, s23
    s_mul_i32 s83, s72, 688128
    s_add_u32 s83, s83, s6
    s_add_u32 m0, s25, 32768
    s_add_u32 s3, s83, 57344
    buffer_load_dwordx4 v54, s[32:35], s3 offen lds
    ds_read_b64_tr_b16 v[56:57], v8 offset:2048
    ds_read_b64_tr_b16 v[58:59], v8 offset:2560
    v_mfma_f32_32x32x16_bf16 v[80:95], v[64:67], v[236:239], v[80:95]
    ds_read_b64_tr_b16 v[60:61], v9 offset:10240
    ds_read_b64_tr_b16 v[62:63], v9 offset:10752
    s_waitcnt lgkmcnt(6)
    v_mfma_f32_32x32x16_bf16 v[96:111], v[68:71], v[236:239], v[96:111]
    s_setprio 2
    s_add_u32 m0, s25, 33792
    s_add_u32 s3, s83, 64512
    buffer_load_dwordx4 v54, s[32:35], s3 offen lds
    ds_read_b64_tr_b16 v[64:65], v8 offset:4096
    ds_read_b64_tr_b16 v[66:67], v8 offset:4608
    v_mfma_f32_32x32x16_bf16 v[80:95], v[72:75], v[240:243], v[80:95]
    ds_read_b64_tr_b16 v[68:69], v9 offset:12288
    ds_read_b64_tr_b16 v[70:71], v9 offset:12800
    s_waitcnt lgkmcnt(6)
    v_mfma_f32_32x32x16_bf16 v[96:111], v[76:79], v[240:243], v[96:111]
    s_add_u32 m0, s25, 34816
    s_add_u32 s3, s83, 71680
    buffer_load_dwordx4 v54, s[32:35], s3 offen lds
    ds_read_b64_tr_b16 v[72:73], v8 offset:6144
    ds_read_b64_tr_b16 v[74:75], v8 offset:6656
    v_mfma_f32_32x32x16_bf16 v[80:95], v[56:59], v[244:247], v[80:95]
    s_setprio 1
    ds_read_b64_tr_b16 v[76:77], v9 offset:14336
    ds_read_b64_tr_b16 v[78:79], v9 offset:14848
    s_waitcnt lgkmcnt(6)
    v_mfma_f32_32x32x16_bf16 v[96:111], v[60:63], v[244:247], v[96:111]
    s_add_u32 m0, s25, 35840
    s_add_u32 s3, s83, 78848
    buffer_load_dwordx4 v54, s[32:35], s3 offen lds
    v_mfma_f32_32x32x16_bf16 v[80:95], v[64:67], v[248:251], v[80:95]
    s_waitcnt lgkmcnt(2)
    v_mfma_f32_32x32x16_bf16 v[96:111], v[68:71], v[248:251], v[96:111]
    s_setprio 0
    s_mul_i32 s25, s70, -81920
    s_add_u32 s25, s25, s23
    s_mul_i32 s83, s72, -688128
    s_add_u32 s83, s83, s6
    s_add_u32 m0, s25, 81920
    s_add_u32 s3, s83, 745472
    buffer_load_dwordx4 v54, s[32:35], s3 offen lds
    v_mfma_f32_32x32x16_bf16 v[80:95], v[72:75], v[252:255], v[80:95]
    s_waitcnt lgkmcnt(0)
    v_mfma_f32_32x32x16_bf16 v[96:111], v[76:79], v[252:255], v[96:111]
    s_add_u32 m0, s25, 82944
    s_add_u32 s3, s83, 752640
    buffer_load_dwordx4 v54, s[32:35], s3 offen lds
    s_setprio 0
    s_waitcnt vmcnt(8)
    s_barrier
    s_mul_i32 s26, s70, -81920
    s_add_u32 s26, s26, 131072
    v_add_u32 v8, s26, v7
    v_xor_b32 v9, 64, v8
    ds_read_b64_tr_b16 v[56:57], v8 offset:0
    ds_read_b64_tr_b16 v[58:59], v8 offset:1024
    ds_read_b64_tr_b16 v[60:61], v9 offset:0
    ds_read_b64_tr_b16 v[62:63], v9 offset:1024
    ds_read_b64_tr_b16 v[64:65], v8 offset:2048
    ds_read_b64_tr_b16 v[66:67], v8 offset:3072
    ds_read_b64_tr_b16 v[68:69], v9 offset:2048
    ds_read_b64_tr_b16 v[70:71], v9 offset:3072
    buffer_atomic_add v5, v52, s[56:59], 0 offen offset:128 sc1
    ds_read_b64_tr_b16 v[72:73], v8 offset:4096
    ds_read_b64_tr_b16 v[74:75], v8 offset:5120
    s_waitcnt lgkmcnt(8)
    v_mfma_f32_32x32x16_bf16 v[112:127], v[56:59], v[144:147], 0
    v_mul_f32 v26, v80, v80
    v_mul_f32 v27, v81, v81
    s_add_u32 m0, s25, 83968
    s_add_u32 s3, s83, 759808
    buffer_load_dwordx4 v54, s[32:35], s3 offen lds
    v_mul_f32 v28, v82, v82
    v_mul_f32 v29, v83, v83
    v_fma_f32 v26, v26, v11, v10
    v_fma_f32 v27, v27, v11, v10
    v_fma_f32 v28, v28, v11, v10
    v_fma_f32 v29, v29, v11, v10
    v_mul_f32 v26, v80, v26
    v_mul_f32 v27, v81, v27
    ds_read_b64_tr_b16 v[76:77], v9 offset:4096
    ds_read_b64_tr_b16 v[78:79], v9 offset:5120
    s_waitcnt lgkmcnt(8)
    v_mfma_f32_32x32x16_bf16 v[128:143], v[60:63], v[144:147], 0
    v_mul_f32 v28, v82, v28
    v_mul_f32 v29, v83, v29
    v_exp_f32 v26, v26
    v_mul_f32 v96, v80, v96
    v_exp_f32 v27, v27
    v_mul_f32 v97, v81, v97
    s_add_u32 m0, s25, 84992
    s_add_u32 s3, s83, 766976
    buffer_load_dwordx4 v54, s[32:35], s3 offen lds
    v_exp_f32 v28, v28
    ds_read_b64_tr_b16 v[56:57], v8 offset:6144
    ds_read_b64_tr_b16 v[58:59], v8 offset:7168
    s_waitcnt lgkmcnt(8)
    v_mfma_f32_32x32x16_bf16 v[112:127], v[64:67], v[148:151], v[112:127]
    v_mul_f32 v98, v82, v98
    v_exp_f32 v29, v29
    v_mul_f32 v99, v83, v99
    v_fma_f32 v26, v26, v12, v12
    v_fma_f32 v27, v27, v12, v12
    v_fma_f32 v28, v28, v12, v12
    v_fma_f32 v29, v29, v12, v12
    v_rcp_f32 v26, v26
    ds_read_b64_tr_b16 v[60:61], v9 offset:6144
    ds_read_b64_tr_b16 v[62:63], v9 offset:7168
    s_waitcnt lgkmcnt(8)
    v_mfma_f32_32x32x16_bf16 v[128:143], v[68:71], v[148:151], v[128:143]
    v_rcp_f32 v27, v27
    s_mul_i32 s25, s70, 98304
    s_add_u32 s25, s25, s23
    s_mov_b32 s83, s7
    s_add_u32 m0, s25, 16384
    s_add_u32 s3, s83, 0
    buffer_load_dwordx4 v54, s[32:35], s3 offen lds
    v_rcp_f32 v28, v28
    v_rcp_f32 v29, v29
    v_mul_f32 v96, v96, v26
    v_mul_f32 v97, v97, v27
    v_mul_f32 v98, v98, v28
    v_mul_f32 v99, v99, v29
    s_mul_i32 s26, s70, 81920
    s_add_u32 s26, s26, 65536
    v_add_u32 v8, s26, v7
    v_xor_b32 v9, 64, v8
    ds_read_b64_tr_b16 v[64:65], v8 offset:0
    ds_read_b64_tr_b16 v[66:67], v8 offset:1024
    s_waitcnt lgkmcnt(8)
    v_mfma_f32_32x32x16_bf16 v[112:127], v[72:75], v[152:155], v[112:127]
    v_cvt_pk_bf16_f32 v32, v96, v97
    v_cvt_pk_bf16_f32 v33, v98, v99
    v_mul_f32 v26, v84, v84
    s_add_u32 m0, s25, 17408
    s_add_u32 s3, s83, 7168
    buffer_load_dwordx4 v54, s[32:35], s3 offen lds
    v_mul_f32 v27, v85, v85
    v_mul_f32 v28, v86, v86
    v_mul_f32 v29, v87, v87
    v_fma_f32 v26, v26, v11, v10
    v_fma_f32 v27, v27, v11, v10
    v_fma_f32 v28, v28, v11, v10
    v_fma_f32 v29, v29, v11, v10
    ds_read_b64_tr_b16 v[68:69], v9 offset:0
    ds_read_b64_tr_b16 v[70:71], v9 offset:1024
    s_waitcnt lgkmcnt(8)
    v_mfma_f32_32x32x16_bf16 v[128:143], v[76:79], v[152:155], v[128:143]
    v_mul_f32 v26, v84, v26
    v_mul_f32 v27, v85, v27
    v_mul_f32 v28, v86, v28
    v_mul_f32 v29, v87, v29
    v_exp_f32 v26, v26
    v_mul_f32 v100, v84, v100
    s_add_u32 m0, s25, 18432
    s_add_u32 s3, s83, 14336
    buffer_load_dwordx4 v54, s[32:35], s3 offen lds
    v_exp_f32 v27, v27
    v_mul_f32 v101, v85, v101
    ds_read_b64_tr_b16 v[72:73], v8 offset:2048
    ds_read_b64_tr_b16 v[74:75], v8 offset:3072
    s_waitcnt lgkmcnt(8)
    v_mfma_f32_32x32x16_bf16 v[112:127], v[56:59], v[156:159], v[112:127]
    v_exp_f32 v28, v28
    v_mul_f32 v102, v86, v102
    v_exp_f32 v29, v29
    v_mul_f32 v103, v87, v103
    v_fma_f32 v26, v26, v12, v12
    v_fma_f32 v27, v27, v12, v12
    v_fma_f32 v28, v28, v12, v12
    v_fma_f32 v29, v29, v12, v12
    ds_read_b64_tr_b16 v[76:77], v9 offset:2048
    ds_read_b64_tr_b16 v[78:79], v9 offset:3072
    s_waitcnt lgkmcnt(8)
    v_mfma_f32_32x32x16_bf16 v[128:143], v[60:63], v[156:159], v[128:143]
    s_add_u32 m0, s25, 19456
    s_add_u32 s3, s83, 21504
    buffer_load_dwordx4 v54, s[32:35], s3 offen lds
    v_rcp_f32 v26, v26
    v_rcp_f32 v27, v27
    v_rcp_f32 v28, v28
    v_rcp_f32 v29, v29
    v_mul_f32 v100, v100, v26
    v_mul_f32 v101, v101, v27
    v_mul_f32 v102, v102, v28
    v_mul_f32 v103, v103, v29
    v_cvt_pk_bf16_f32 v34, v100, v101
    v_cvt_pk_bf16_f32 v35, v102, v103
    buffer_store_dwordx4 v[32:35], v1, s[56:59], s99 offen sc0 sc1
    s_barrier
    ds_read_b64_tr_b16 v[56:57], v8 offset:4096
    ds_read_b64_tr_b16 v[58:59], v8 offset:5120
    s_waitcnt lgkmcnt(8)
    v_mfma_f32_32x32x16_bf16 v[112:127], v[64:67], v[160:163], v[112:127]
    v_mul_f32 v26, v88, v88
    v_mul_f32 v27, v89, v89
    v_mul_f32 v28, v90, v90
    v_mul_f32 v29, v91, v91
    s_mul_i32 s25, s70, -81920
    s_add_u32 s25, s25, s23
    s_xor_b32 s83, s73, 0
    s_mul_i32 s83, s83, s9
    s_add_u32 s83, s83, s8
    s_add_u32 m0, s25, 131072
    s_add_u32 s3, s83, 0
    buffer_load_dwordx4 v4, s[36:39], s3 offen lds
    v_fma_f32 v26, v26, v11, v10
    v_fma_f32 v27, v27, v11, v10
    v_fma_f32 v28, v28, v11, v10
    v_fma_f32 v29, v29, v11, v10
    v_mul_f32 v26, v88, v26
    v_mul_f32 v27, v89, v27
    ds_read_b64_tr_b16 v[60:61], v9 offset:4096
    ds_read_b64_tr_b16 v[62:63], v9 offset:5120
    s_waitcnt lgkmcnt(8)
    v_mfma_f32_32x32x16_bf16 v[128:143], v[68:71], v[160:163], v[128:143]
    v_mul_f32 v28, v90, v28
    v_mul_f32 v29, v91, v29
    v_exp_f32 v26, v26
    v_mul_f32 v104, v88, v104
    v_exp_f32 v27, v27
    v_mul_f32 v105, v89, v105
    v_exp_f32 v28, v28
    ds_read_b64_tr_b16 v[64:65], v8 offset:6144
    ds_read_b64_tr_b16 v[66:67], v8 offset:7168
    s_waitcnt lgkmcnt(8)
    v_mfma_f32_32x32x16_bf16 v[112:127], v[72:75], v[164:167], v[112:127]
    v_mul_f32 v106, v90, v106
    v_exp_f32 v29, v29
    s_add_u32 m0, s25, 132096
    s_add_u32 s3, s83, 7168
    buffer_load_dwordx4 v4, s[36:39], s3 offen lds
    v_mul_f32 v107, v91, v107
    v_fma_f32 v26, v26, v12, v12
    v_fma_f32 v27, v27, v12, v12
    v_fma_f32 v28, v28, v12, v12
    v_fma_f32 v29, v29, v12, v12
    v_rcp_f32 v26, v26
    ds_read_b64_tr_b16 v[68:69], v9 offset:6144
    ds_read_b64_tr_b16 v[70:71], v9 offset:7168
    s_waitcnt lgkmcnt(8)
    v_mfma_f32_32x32x16_bf16 v[128:143], v[76:79], v[164:167], v[128:143]
    v_rcp_f32 v27, v27
    v_rcp_f32 v28, v28
    v_rcp_f32 v29, v29
    v_mul_f32 v104, v104, v26
    v_mul_f32 v105, v105, v27
    v_mul_f32 v106, v106, v28
    v_mul_f32 v107, v107, v29
    s_waitcnt vmcnt(17) lgkmcnt(6)
    v_mfma_f32_32x32x16_bf16 v[112:127], v[56:59], v[168:171], v[112:127]
    v_cvt_pk_bf16_f32 v36, v104, v105
    v_cvt_pk_bf16_f32 v37, v106, v107
    v_mul_f32 v26, v92, v92
    v_mul_f32 v27, v93, v93
    s_add_u32 m0, s25, 133120
    s_add_u32 s3, s83, 14336
    buffer_load_dwordx4 v4, s[36:39], s3 offen lds
    v_mul_f32 v28, v94, v94
    v_mul_f32 v29, v95, v95
    v_fma_f32 v26, v26, v11, v10
    v_fma_f32 v27, v27, v11, v10
    v_fma_f32 v28, v28, v11, v10
    v_fma_f32 v29, v29, v11, v10
    s_waitcnt lgkmcnt(4)
    v_mfma_f32_32x32x16_bf16 v[128:143], v[60:63], v[168:171], v[128:143]
    v_mul_f32 v26, v92, v26
    v_mul_f32 v27, v93, v27
    v_mul_f32 v28, v94, v28
    v_mul_f32 v29, v95, v29
    v_exp_f32 v26, v26
    v_mul_f32 v108, v92, v108
    v_exp_f32 v27, v27
    v_mul_f32 v109, v93, v109
    s_waitcnt vmcnt(17) lgkmcnt(2)
    v_mfma_f32_32x32x16_bf16 v[112:127], v[64:67], v[172:175], v[112:127]
    v_exp_f32 v28, v28
    v_mul_f32 v110, v94, v110
    v_exp_f32 v29, v29
    v_mul_f32 v111, v95, v111
    v_fma_f32 v26, v26, v12, v12
    v_fma_f32 v27, v27, v12, v12
    s_add_u32 m0, s25, 134144
    s_add_u32 s3, s83, 21504
    buffer_load_dwordx4 v4, s[36:39], s3 offen lds
    v_fma_f32 v28, v28, v12, v12
    v_fma_f32 v29, v29, v12, v12
    s_waitcnt lgkmcnt(0)
    v_mfma_f32_32x32x16_bf16 v[128:143], v[68:71], v[172:175], v[128:143]
    v_rcp_f32 v26, v26
    v_rcp_f32 v27, v27
    v_rcp_f32 v28, v28
    v_rcp_f32 v29, v29
    v_mul_f32 v108, v108, v26
    v_mul_f32 v109, v109, v27
    v_mul_f32 v110, v110, v28
    v_mul_f32 v111, v111, v29
    v_cvt_pk_bf16_f32 v38, v108, v109
    v_cvt_pk_bf16_f32 v39, v110, v111
    buffer_store_dwordx4 v[36:39], v1, s[56:59], s99 offen offset:1024 sc0 sc1
    s_barrier
    buffer_load_dword v53, v52, s[56:59], 0 offen offset:128 sc1
    s_mul_i32 s25, s70, 81920
    s_add_u32 s25, s25, s23
    s_xor_b32 s83, s73, 1
    s_mul_i32 s83, s83, s9
    s_add_u32 s83, s83, s8
    s_add_u32 m0, s25, 65536
    s_add_u32 s3, s83, 0
    buffer_load_dwordx4 v4, s[36:39], s3 offen lds
    s_add_u32 m0, s25, 66560
    s_add_u32 s3, s83, 7168
    buffer_load_dwordx4 v4, s[36:39], s3 offen lds
    s_add_u32 m0, s25, 67584
    s_add_u32 s3, s83, 14336
    buffer_load_dwordx4 v4, s[36:39], s3 offen lds
    s_add_u32 m0, s25, 68608
    s_add_u32 s3, s83, 21504
    buffer_load_dwordx4 v4, s[36:39], s3 offen lds
    s_waitcnt vmcnt(5)
    s_barrier
    buffer_atomic_add v5, v52, s[56:59], 0 offen offset:256 sc1
    s_waitcnt vmcnt(5)
    v_lshrrev_b32 v53, 3, v53
    v_cmp_gt_u32 vcc, v5, v53
    s_cbranch_vccnz R_P1F
B_P1F:
    s_barrier
    s_mul_i32 s26, s70, 65536
    s_add_u32 s26, s26, 32768
    v_add_u32 v8, s26, v7
    v_xor_b32 v9, 64, v8
    ds_read_b64_tr_b16 v[72:73], v8 offset:0
    ds_read_b64_tr_b16 v[74:75], v8 offset:1024
    ds_read_b64_tr_b16 v[76:77], v9 offset:0
    ds_read_b64_tr_b16 v[78:79], v9 offset:1024
    ds_read_b64_tr_b16 v[56:57], v8 offset:2048
    ds_read_b64_tr_b16 v[58:59], v8 offset:3072
    ds_read_b64_tr_b16 v[60:61], v9 offset:2048
    ds_read_b64_tr_b16 v[62:63], v9 offset:3072
    buffer_load_dword v53, v52, s[56:59], 0 offen offset:512 sc1
    s_mul_i32 s84, s72, 49152
    s_add_u32 s84, s84, s14
    s_add_u32 s84, s84, 4096
    buffer_load_dwordx4 v[176:179], v1, s[56:59], s84 offen offset:0 sc1
    buffer_load_dwordx4 v[180:183], v1, s[56:59], s84 offen offset:1024 sc1
    buffer_load_dwordx4 v[184:187], v1, s[56:59], s84 offen offset:2048 sc1
    buffer_load_dwordx4 v[188:191], v1, s[56:59], s84 offen offset:3072 sc1
    s_mul_i32 s84, s72, -49152
    s_add_u32 s84, s84, s14
    s_add_u32 s84, s84, 53248
    buffer_load_dwordx4 v[192:195], v1, s[56:59], s84 offen offset:0 sc1
    buffer_load_dwordx4 v[196:199], v1, s[56:59], s84 offen offset:1024 sc1
    buffer_load_dwordx4 v[200:203], v1, s[56:59], s84 offen offset:2048 sc1
    buffer_load_dwordx4 v[204:207], v1, s[56:59], s84 offen offset:3072 sc1
    s_waitcnt vmcnt(8)
    v_lshrrev_b32 v53, 3, v53
    v_cmp_gt_u32 vcc, v5, v53
    s_cbranch_vccnz R_P4F
B_P4F:
    s_barrier
    ds_read_b64_tr_b16 v[64:65], v8 offset:4096
    ds_read_b64_tr_b16 v[66:67], v8 offset:5120
    s_waitcnt vmcnt(7) lgkmcnt(8)
    v_mfma_f32_32x32x16_bf16 v[112:127], v[72:75], v[176:179], v[112:127]
    s_mov_b32 s84, s15
    buffer_load_dwordx4 v[208:211], v1, s[56:59], s84 offen offset:0 sc1
    ds_read_b64_tr_b16 v[68:69], v9 offset:4096
    ds_read_b64_tr_b16 v[70:71], v9 offset:5120
    s_waitcnt lgkmcnt(8)
    v_mfma_f32_32x32x16_bf16 v[128:143], v[76:79], v[176:179], v[128:143]
    buffer_load_dwordx4 v[212:215], v1, s[56:59], s84 offen offset:1024 sc1
    ds_read_b64_tr_b16 v[72:73], v8 offset:6144
    ds_read_b64_tr_b16 v[74:75], v8 offset:7168
    s_waitcnt vmcnt(8) lgkmcnt(8)
    v_mfma_f32_32x32x16_bf16 v[112:127], v[56:59], v[180:183], v[112:127]
    ds_read_b64_tr_b16 v[76:77], v9 offset:6144
    ds_read_b64_tr_b16 v[78:79], v9 offset:7168
    s_waitcnt lgkmcnt(8)
    v_mfma_f32_32x32x16_bf16 v[128:143], v[60:63], v[180:183], v[128:143]
    buffer_load_dwordx4 v[216:219], v1, s[56:59], s84 offen offset:2048 sc1
    s_mul_i32 s26, s70, -81920
    s_add_u32 s26, s26, 81920
    v_add_u32 v8, s26, v7
    v_xor_b32 v9, 64, v8
    ds_read_b64_tr_b16 v[56:57], v8 offset:0
    ds_read_b64_tr_b16 v[58:59], v8 offset:1024
    s_waitcnt vmcnt(8) lgkmcnt(8)
    v_mfma_f32_32x32x16_bf16 v[112:127], v[64:67], v[184:187], v[112:127]
    ds_read_b64_tr_b16 v[60:61], v9 offset:0
    ds_read_b64_tr_b16 v[62:63], v9 offset:1024
    s_waitcnt lgkmcnt(8)
    v_mfma_f32_32x32x16_bf16 v[128:143], v[68:71], v[184:187], v[128:143]
    buffer_load_dwordx4 v[220:223], v1, s[56:59], s84 offen offset:3072 sc1
    ds_read_b64_tr_b16 v[64:65], v8 offset:2048
    ds_read_b64_tr_b16 v[66:67], v8 offset:3072
    s_waitcnt vmcnt(8) lgkmcnt(8)
    v_mfma_f32_32x32x16_bf16 v[112:127], v[72:75], v[188:191], v[112:127]
    ds_read_b64_tr_b16 v[68:69], v9 offset:2048
    ds_read_b64_tr_b16 v[70:71], v9 offset:3072
    s_waitcnt lgkmcnt(8)
    v_mfma_f32_32x32x16_bf16 v[128:143], v[76:79], v[188:191], v[128:143]
    s_barrier
    s_cmp_eq_u32 s70, 1
    s_cbranch_scc1 KM_VF
    ds_read_b64_tr_b16 v[72:73], v8 offset:4096
    ds_read_b64_tr_b16 v[74:75], v8 offset:5120
    s_waitcnt vmcnt(7) lgkmcnt(8)
    v_mfma_f32_32x32x16_bf16 v[112:127], v[56:59], v[192:195], v[112:127]
    buffer_load_dword v53, v52, s[56:59], 0 offen offset:384 sc1
    ds_read_b64_tr_b16 v[76:77], v9 offset:4096
    ds_read_b64_tr_b16 v[78:79], v9 offset:5120
    s_waitcnt lgkmcnt(8)
    v_mfma_f32_32x32x16_bf16 v[128:143], v[60:63], v[192:195], v[128:143]
    s_mul_i32 s25, s70, 65536
    s_add_u32 s25, s25, s23
    s_xor_b32 s83, s73, 2
    s_mul_i32 s83, s83, s9
    s_add_u32 s83, s83, s8
    s_add_u32 m0, s25, 32768
    s_add_u32 s3, s83, 0
    buffer_load_dwordx4 v4, s[36:39], s3 offen lds
    ds_read_b64_tr_b16 v[56:57], v8 offset:6144
    ds_read_b64_tr_b16 v[58:59], v8 offset:7168
    s_waitcnt vmcnt(8) lgkmcnt(8)
    v_mfma_f32_32x32x16_bf16 v[112:127], v[64:67], v[196:199], v[112:127]
    ds_read_b64_tr_b16 v[60:61], v9 offset:6144
    ds_read_b64_tr_b16 v[62:63], v9 offset:7168
    s_waitcnt lgkmcnt(8)
    v_mfma_f32_32x32x16_bf16 v[128:143], v[68:71], v[196:199], v[128:143]
    s_add_u32 m0, s25, 33792
    s_add_u32 s3, s83, 7168
    buffer_load_dwordx4 v4, s[36:39], s3 offen lds
    s_mul_i32 s26, s70, 98304
    s_add_u32 s26, s26, 16384
    v_add_u32 v8, s26, v7
    v_xor_b32 v9, 64, v8
    ds_read_b64_tr_b16 v[64:65], v8 offset:0
    ds_read_b64_tr_b16 v[66:67], v8 offset:1024
    s_waitcnt vmcnt(8) lgkmcnt(8)
    v_mfma_f32_32x32x16_bf16 v[112:127], v[72:75], v[200:203], v[112:127]
    s_add_u32 m0, s25, 34816
    s_add_u32 s3, s83, 14336
    buffer_load_dwordx4 v4, s[36:39], s3 offen lds
    ds_read_b64_tr_b16 v[68:69], v9 offset:0
    ds_read_b64_tr_b16 v[70:71], v9 offset:1024
    s_waitcnt lgkmcnt(8)
    v_mfma_f32_32x32x16_bf16 v[128:143], v[76:79], v[200:203], v[128:143]
    ds_read_b64_tr_b16 v[72:73], v8 offset:2048
    ds_read_b64_tr_b16 v[74:75], v8 offset:3072
    s_waitcnt vmcnt(8) lgkmcnt(8)
    v_mfma_f32_32x32x16_bf16 v[112:127], v[56:59], v[204:207], v[112:127]
    s_add_u32 m0, s25, 35840
    s_add_u32 s3, s83, 21504
    buffer_load_dwordx4 v4, s[36:39], s3 offen lds
    ds_read_b64_tr_b16 v[76:77], v9 offset:2048
    ds_read_b64_tr_b16 v[78:79], v9 offset:3072
    s_waitcnt lgkmcnt(8)
    v_mfma_f32_32x32x16_bf16 v[128:143], v[60:63], v[204:207], v[128:143]
    s_waitcnt vmcnt(4)
    v_lshrrev_b32 v53, 3, v53
    v_cmp_gt_u32 vcc, v5, v53
    s_cbranch_vccnz R_P3F
B_P3F:
    s_barrier
    ds_read_b64_tr_b16 v[56:57], v8 offset:4096
    ds_read_b64_tr_b16 v[58:59], v8 offset:5120
    s_waitcnt lgkmcnt(8)
    v_mfma_f32_32x32x16_bf16 v[112:127], v[64:67], v[208:211], v[112:127]
    s_mul_i32 s25, s70, -81920
    s_add_u32 s25, s25, s23
    s_xor_b32 s83, s73, 3
    s_mul_i32 s83, s83, s9
    s_add_u32 s83, s83, s8
    s_add_u32 m0, s25, 81920
    s_add_u32 s3, s83, 0
    buffer_load_dwordx4 v4, s[36:39], s3 offen lds
    s_add_u32 m0, s25, 82944
    s_add_u32 s3, s83, 7168
    buffer_load_dwordx4 v4, s[36:39], s3 offen lds
    ds_read_b64_tr_b16 v[60:61], v9 offset:4096
    ds_read_b64_tr_b16 v[62:63], v9 offset:5120
    s_waitcnt lgkmcnt(8)
    v_mfma_f32_32x32x16_bf16 v[128:143], v[68:71], v[208:211], v[128:143]
    s_add_u32 m0, s25, 83968
    s_add_u32 s3, s83, 14336
    buffer_load_dwordx4 v4, s[36:39], s3 offen lds
    ds_read_b64_tr_b16 v[64:65], v8 offset:6144
    ds_read_b64_tr_b16 v[66:67], v8 offset:7168
    s_waitcnt lgkmcnt(8)
    v_mfma_f32_32x32x16_bf16 v[112:127], v[72:75], v[212:215], v[112:127]
    s_add_u32 m0, s25, 84992
    s_add_u32 s3, s83, 21504
    buffer_load_dwordx4 v4, s[36:39], s3 offen lds
    s_xor_b32 s84, s73, 0
    s_mul_i32 s84, s84, s17
    s_add_u32 s84, s84, s16
    buffer_load_dwordx4 v[224:227], v1, s[56:59], s84 offen offset:0 sc1
    ds_read_b64_tr_b16 v[68:69], v9 offset:6144
    ds_read_b64_tr_b16 v[70:71], v9 offset:7168
    s_waitcnt lgkmcnt(8)
    v_mfma_f32_32x32x16_bf16 v[128:143], v[76:79], v[212:215], v[128:143]
    buffer_load_dwordx4 v[228:231], v1, s[56:59], s84 offen offset:1024 sc1
    s_waitcnt lgkmcnt(6)
    v_mfma_f32_32x32x16_bf16 v[112:127], v[56:59], v[216:219], v[112:127]
    buffer_load_dwordx4 v[232:235], v1, s[56:59], s84 offen offset:2048 sc1
    buffer_load_dwordx4 v[236:239], v1, s[56:59], s84 offen offset:3072 sc1
    s_waitcnt lgkmcnt(4)
    v_mfma_f32_32x32x16_bf16 v[128:143], v[60:63], v[216:219], v[128:143]
    s_xor_b32 s84, s73, 1
    s_mul_i32 s84, s84, s17
    s_add_u32 s84, s84, s16
    buffer_load_dwordx4 v[240:243], v1, s[56:59], s84 offen offset:0 sc1
    s_waitcnt lgkmcnt(2)
    v_mfma_f32_32x32x16_bf16 v[112:127], v[64:67], v[220:223], v[112:127]
    buffer_load_dwordx4 v[244:247], v1, s[56:59], s84 offen offset:1024 sc1
    buffer_load_dwordx4 v[248:251], v1, s[56:59], s84 offen offset:2048 sc1
    s_waitcnt lgkmcnt(0)
    v_mfma_f32_32x32x16_bf16 v[128:143], v[68:71], v[220:223], v[128:143]
    buffer_load_dwordx4 v[252:255], v1, s[56:59], s84 offen offset:3072 sc1
    s_barrier
    v_add_u32 v32, 131072, v7
    v_xor_b32 v33, 64, v32
    v_add_u32 v34, 65536, v7
    v_xor_b32 v35, 64, v34
    s_bitcmp1_b32 s68, 1
    s_cselect_b32 s26, 7, 1
    s_lshl_b32 s26, s26, 14
    v_add_u32 v15, s26, v20
    v_xor_b32 v16, 32, v15
    v_xor_b32 v17, 64, v15
    v_xor_b32 v18, 96, v15
    ds_read_b64_tr_b16 v[56:57], v32 offset:0
    ds_read_b64_tr_b16 v[58:59], v32 offset:1024
    ds_read_b64_tr_b16 v[60:61], v33 offset:0
    ds_read_b64_tr_b16 v[62:63], v33 offset:1024
    ds_read_b64_tr_b16 v[64:65], v32 offset:2048
    ds_read_b64_tr_b16 v[66:67], v32 offset:3072
    ds_read_b64_tr_b16 v[68:69], v33 offset:2048
    ds_read_b64_tr_b16 v[70:71], v33 offset:3072
    s_waitcnt vmcnt(7) lgkmcnt(6)
    v_mfma_f32_32x32x16_bf16 v[80:95], v[56:59], v[224:227], 0
    s_xor_b32 s84, s73, 2
    s_mul_i32 s84, s84, s17
    s_add_u32 s84, s84, s16
    buffer_load_dwordx4 v[144:147], v1, s[56:59], s84 offen offset:0 sc1
    ds_read_b64_tr_b16 v[176:177], v32 offset:4096
    ds_read_b64_tr_b16 v[178:179], v32 offset:5120
    ds_read_b64_tr_b16 v[180:181], v33 offset:4096
    ds_read_b64_tr_b16 v[182:183], v33 offset:5120
    s_waitcnt lgkmcnt(8)
    v_mfma_f32_32x32x16_bf16 v[96:111], v[60:63], v[224:227], 0
    buffer_load_dwordx4 v[148:151], v1, s[56:59], s84 offen offset:1024 sc1
    ds_read_b64_tr_b16 v[184:185], v32 offset:6144
    ds_read_b64_tr_b16 v[186:187], v32 offset:7168
    ds_read_b64_tr_b16 v[188:189], v33 offset:6144
    ds_read_b64_tr_b16 v[190:191], v33 offset:7168
    s_waitcnt vmcnt(8) lgkmcnt(10)
    v_mfma_f32_32x32x16_bf16 v[80:95], v[64:67], v[228:231], v[80:95]
    buffer_load_dwordx4 v[152:155], v1, s[56:59], s84 offen offset:2048 sc1
    ds_read_b64_tr_b16 v[192:193], v34 offset:0
    ds_read_b64_tr_b16 v[194:195], v34 offset:1024
    ds_read_b64_tr_b16 v[196:197], v35 offset:0
    ds_read_b64_tr_b16 v[198:199], v35 offset:1024
    s_waitcnt lgkmcnt(12)
    v_mfma_f32_32x32x16_bf16 v[96:111], v[68:71], v[228:231], v[96:111]
    buffer_load_dwordx4 v[156:159], v1, s[56:59], s84 offen offset:3072 sc1
    ds_read_b64_tr_b16 v[200:201], v34 offset:2048
    ds_read_b64_tr_b16 v[202:203], v34 offset:3072
    ds_read_b64_tr_b16 v[204:205], v35 offset:2048
    ds_read_b64_tr_b16 v[206:207], v35 offset:3072
    s_waitcnt vmcnt(9) lgkmcnt(14)
    v_mfma_f32_32x32x16_bf16 v[80:95], v[176:179], v[232:235], v[80:95]
    ds_read_b64_tr_b16 v[208:209], v34 offset:4096
    ds_read_b64_tr_b16 v[210:211], v34 offset:5120
    ds_read_b64_tr_b16 v[212:213], v35 offset:4096
    ds_read_b64_tr_b16 v[214:215], v35 offset:5120
    s_waitcnt lgkmcnt(15)
    v_mfma_f32_32x32x16_bf16 v[96:111], v[180:183], v[232:235], v[96:111]
    s_xor_b32 s84, s73, 3
    s_mul_i32 s84, s84, s17
    s_add_u32 s84, s84, s16
    buffer_load_dwordx4 v[160:163], v1, s[56:59], s84 offen offset:0 sc1
    ds_read_b64_tr_b16 v[216:217], v34 offset:6144
    ds_read_b64_tr_b16 v[218:219], v34 offset:7168
    ds_read_b64_tr_b16 v[220:221], v35 offset:6144
    ds_read_b64_tr_b16 v[222:223], v35 offset:7168
    s_waitcnt vmcnt(9) lgkmcnt(15)
    v_mfma_f32_32x32x16_bf16 v[80:95], v[184:187], v[236:239], v[80:95]
    buffer_load_dwordx4 v[164:167], v1, s[56:59], s84 offen offset:1024 sc1
    s_waitcnt lgkmcnt(15)
    v_mfma_f32_32x32x16_bf16 v[96:111], v[188:191], v[236:239], v[96:111]
    buffer_load_dwordx4 v[168:171], v1, s[56:59], s84 offen offset:2048 sc1
    s_waitcnt vmcnt(10) lgkmcnt(14)
    v_mfma_f32_32x32x16_bf16 v[80:95], v[192:195], v[240:243], v[80:95]
    ds_write_b128 v15, v[112:115] offset:0
    s_waitcnt lgkmcnt(13)
    v_mfma_f32_32x32x16_bf16 v[96:111], v[196:199], v[240:243], v[96:111]
    buffer_load_dwordx4 v[172:175], v1, s[56:59], s84 offen offset:3072 sc1
    ds_write_b128 v16, v[116:119] offset:0
    s_waitcnt vmcnt(10) lgkmcnt(12)
    v_mfma_f32_32x32x16_bf16 v[80:95], v[200:203], v[244:247], v[80:95]
    buffer_load_dwordx4 v[22:25], v21, s[28:31], 0 offen
    ds_write_b128 v17, v[120:123] offset:0
    s_waitcnt lgkmcnt(11)
    v_mfma_f32_32x32x16_bf16 v[96:111], v[204:207], v[244:247], v[96:111]
    ds_write_b128 v18, v[124:127] offset:0
    s_waitcnt vmcnt(10) lgkmcnt(10)
    v_mfma_f32_32x32x16_bf16 v[80:95], v[208:211], v[248:251], v[80:95]
    ds_write_b128 v15, v[128:131] offset:128
    s_waitcnt lgkmcnt(9)
    v_mfma_f32_32x32x16_bf16 v[96:111], v[212:215], v[248:251], v[96:111]
    ds_write_b128 v16, v[132:135] offset:128
    s_waitcnt vmcnt(9) lgkmcnt(8)
    v_mfma_f32_32x32x16_bf16 v[80:95], v[216:219], v[252:255], v[80:95]
    ds_write_b128 v17, v[136:139] offset:128
    s_waitcnt lgkmcnt(7)
    v_mfma_f32_32x32x16_bf16 v[96:111], v[220:223], v[252:255], v[96:111]
    ds_write_b128 v18, v[140:143] offset:128
    s_waitcnt lgkmcnt(0)
    s_barrier
    v_add_u32 v36, 32768, v7
    v_xor_b32 v37, 64, v36
    v_add_u32 v38, 81920, v7
    v_xor_b32 v39, 64, v38
    s_bitcmp1_b32 s68, 1
    s_cselect_b32 s26, 4, 8
    s_lshl_b32 s26, s26, 14
    v_add_u32 v15, s26, v20
    v_xor_b32 v16, 32, v15
    v_xor_b32 v17, 64, v15
    v_xor_b32 v18, 96, v15
    ds_read_b64_tr_b16 v[56:57], v36 offset:0
    ds_read_b64_tr_b16 v[58:59], v36 offset:1024
    ds_read_b64_tr_b16 v[60:61], v36 offset:2048
    ds_read_b64_tr_b16 v[62:63], v36 offset:3072
    ds_read_b64_tr_b16 v[64:65], v36 offset:4096
    ds_read_b64_tr_b16 v[66:67], v36 offset:5120
    ds_read_b64_tr_b16 v[68:69], v36 offset:6144
    ds_read_b64_tr_b16 v[70:71], v36 offset:7168
    s_waitcnt vmcnt(8) lgkmcnt(6)
    v_mfma_f32_32x32x16_bf16 v[80:95], v[56:59], v[144:147], v[80:95]
    ds_read_b64_tr_b16 v[176:177], v38 offset:0
    ds_read_b64_tr_b16 v[178:179], v38 offset:1024
    ds_read_b64_tr_b16 v[180:181], v38 offset:2048
    ds_read_b64_tr_b16 v[182:183], v38 offset:3072
    s_waitcnt vmcnt(7) lgkmcnt(8)
    v_mfma_f32_32x32x16_bf16 v[80:95], v[60:63], v[148:151], v[80:95]
    ds_read_b64_tr_b16 v[184:185], v38 offset:4096
    ds_read_b64_tr_b16 v[186:187], v38 offset:5120
    ds_read_b64_tr_b16 v[188:189], v38 offset:6144
    ds_read_b64_tr_b16 v[190:191], v38 offset:7168
    s_waitcnt vmcnt(6) lgkmcnt(10)
    v_mfma_f32_32x32x16_bf16 v[80:95], v[64:67], v[152:155], v[80:95]
    ds_read_b64_tr_b16 v[192:193], v37 offset:0
    ds_read_b64_tr_b16 v[194:195], v37 offset:1024
    ds_read_b64_tr_b16 v[196:197], v37 offset:2048
    ds_read_b64_tr_b16 v[198:199], v37 offset:3072
    s_waitcnt vmcnt(5) lgkmcnt(12)
    v_mfma_f32_32x32x16_bf16 v[80:95], v[68:71], v[156:159], v[80:95]
    ds_read_b64_tr_b16 v[200:201], v37 offset:4096
    ds_read_b64_tr_b16 v[202:203], v37 offset:5120
    ds_read_b64_tr_b16 v[204:205], v37 offset:6144
    ds_read_b64_tr_b16 v[206:207], v37 offset:7168
    s_waitcnt vmcnt(4) lgkmcnt(14)
    v_mfma_f32_32x32x16_bf16 v[80:95], v[176:179], v[160:163], v[80:95]
    ds_read_b64_tr_b16 v[208:209], v39 offset:0
    ds_read_b64_tr_b16 v[210:211], v39 offset:1024
    ds_read_b64_tr_b16 v[212:213], v39 offset:2048
    ds_read_b64_tr_b16 v[214:215], v39 offset:3072
    s_waitcnt vmcnt(3) lgkmcnt(15)
    v_mfma_f32_32x32x16_bf16 v[80:95], v[180:183], v[164:167], v[80:95]
    ds_read_b64_tr_b16 v[216:217], v39 offset:4096
    ds_read_b64_tr_b16 v[218:219], v39 offset:5120
    ds_read_b64_tr_b16 v[220:221], v39 offset:6144
    ds_read_b64_tr_b16 v[222:223], v39 offset:7168
    s_waitcnt vmcnt(2) lgkmcnt(15)
    v_mfma_f32_32x32x16_bf16 v[80:95], v[184:187], v[168:171], v[80:95]
    s_waitcnt vmcnt(1) lgkmcnt(15)
    v_mfma_f32_32x32x16_bf16 v[80:95], v[188:191], v[172:175], v[80:95]
    s_waitcnt lgkmcnt(14)
    v_mfma_f32_32x32x16_bf16 v[96:111], v[192:195], v[144:147], v[96:111]
    s_waitcnt lgkmcnt(12)
    v_mfma_f32_32x32x16_bf16 v[96:111], v[196:199], v[148:151], v[96:111]
    s_waitcnt lgkmcnt(10)
    v_mfma_f32_32x32x16_bf16 v[96:111], v[200:203], v[152:155], v[96:111]
    s_nop 5
    ds_write_b128 v15, v[80:83] offset:0
    s_waitcnt lgkmcnt(9)
    v_mfma_f32_32x32x16_bf16 v[96:111], v[204:207], v[156:159], v[96:111]
    ds_write_b128 v16, v[84:87] offset:0
    s_waitcnt lgkmcnt(8)
    v_mfma_f32_32x32x16_bf16 v[96:111], v[208:211], v[160:163], v[96:111]
    ds_write_b128 v17, v[88:91] offset:0
    s_waitcnt lgkmcnt(7)
    v_mfma_f32_32x32x16_bf16 v[96:111], v[212:215], v[164:167], v[96:111]
    ds_write_b128 v18, v[92:95] offset:0
    s_waitcnt lgkmcnt(6)
    v_mfma_f32_32x32x16_bf16 v[96:111], v[216:219], v[168:171], v[96:111]
    s_waitcnt lgkmcnt(4)
    v_mfma_f32_32x32x16_bf16 v[96:111], v[220:223], v[172:175], v[96:111]
    v_add_u32 v32, 16384, v19
    v_xor_b32 v33, 16, v32
    v_add_u32 v34, 114688, v19
    v_xor_b32 v35, 16, v34
    v_add_u32 v36, 49152, v19
    v_xor_b32 v37, 16, v36
    v_add_u32 v38, 147456, v19
    v_xor_b32 v39, 16, v38
    s_nop 3
    ds_write_b128 v15, v[96:99] offset:128
    ds_write_b128 v16, v[100:103] offset:128
    ds_write_b128 v17, v[104:107] offset:128
    ds_write_b128 v18, v[108:111] offset:128
    v_add_u32 v40, 131072, v19
    v_xor_b32 v41, 16, v40
    v_add_u32 v42, 65536, v19
    v_xor_b32 v43, 16, v42
    v_mov_b32 v30, 0xbfb8aa3b
    v_mov_b32 v31, 1.0
    s_waitcnt vmcnt(0)
    v_lshlrev_b32 v184, 16, v22
    v_and_b32 v185, 0xffff0000, v22
    v_lshlrev_b32 v186, 16, v23
    v_and_b32 v187, 0xffff0000, v23
    v_lshlrev_b32 v188, 16, v24
    v_and_b32 v189, 0xffff0000, v24
    v_lshlrev_b32 v190, 16, v25
    v_and_b32 v191, 0xffff0000, v25
    s_waitcnt lgkmcnt(0)
    s_barrier
    ds_read_b128 v[176:179], v32
    ds_read_b128 v[180:183], v33
    ds_read_b128 v[224:227], v34
    ds_read_b128 v[228:231], v35
    ds_read_b128 v[208:211], v36
    ds_read_b128 v[212:215], v37
    ds_read_b128 v[216:219], v38
    ds_read_b128 v[220:223], v39
    ds_read_b128 v[192:195], v40
    ds_read_b128 v[196:199], v41
    ds_read_b128 v[200:203], v42
    ds_read_b128 v[204:207], v43
    s_waitcnt lgkmcnt(9)
    v_pk_add_f32 v[176:177], v[176:177], v[224:225]
    v_pk_add_f32 v[178:179], v[178:179], v[226:227]
    s_waitcnt lgkmcnt(8)
    v_pk_add_f32 v[180:181], v[180:181], v[228:229]
    v_pk_add_f32 v[182:183], v[182:183], v[230:231]
    s_waitcnt lgkmcnt(5)
    v_pk_add_f32 v[208:209], v[208:209], v[216:217]
    v_pk_add_f32 v[210:211], v[210:211], v[218:219]
    s_waitcnt lgkmcnt(4)
    v_pk_add_f32 v[212:213], v[212:213], v[220:221]
    v_pk_add_f32 v[214:215], v[214:215], v[222:223]
    v_pk_add_f32 v[176:177], v[176:177], v[208:209]
    v_pk_add_f32 v[178:179], v[178:179], v[210:211]
    v_pk_add_f32 v[180:181], v[180:181], v[212:213]
    v_pk_add_f32 v[182:183], v[182:183], v[214:215]
    v_pk_mul_f32 v[208:209], v[176:177], v[30:31] op_sel_hi:[1,0]
    v_pk_mul_f32 v[210:211], v[178:179], v[30:31] op_sel_hi:[1,0]
    v_pk_mul_f32 v[212:213], v[180:181], v[30:31] op_sel_hi:[1,0]
    v_pk_mul_f32 v[214:215], v[182:183], v[30:31] op_sel_hi:[1,0]
    v_exp_f32 v208, v208
    v_exp_f32 v209, v209
    s_waitcnt lgkmcnt(1)
    v_pk_add_f32 v[192:193], v[192:193], v[200:201]
    v_exp_f32 v210, v210
    v_exp_f32 v211, v211
    v_pk_add_f32 v[194:195], v[194:195], v[202:203]
    v_exp_f32 v212, v212
    v_exp_f32 v213, v213
    s_waitcnt lgkmcnt(0)
    v_pk_add_f32 v[196:197], v[196:197], v[204:205]
    v_exp_f32 v214, v214
    v_exp_f32 v215, v215
    v_pk_add_f32 v[198:199], v[198:199], v[206:207]
    v_pk_add_f32 v[208:209], v[208:209], v[30:31] op_sel:[0,1] op_sel_hi:[1,1]
    v_pk_add_f32 v[210:211], v[210:211], v[30:31] op_sel:[0,1] op_sel_hi:[1,1]
    v_pk_add_f32 v[212:213], v[212:213], v[30:31] op_sel:[0,1] op_sel_hi:[1,1]
    v_pk_add_f32 v[214:215], v[214:215], v[30:31] op_sel:[0,1] op_sel_hi:[1,1]
    v_rcp_f32 v208, v208
    v_rcp_f32 v209, v209
    v_pk_mul_f32 v[176:177], v[176:177], v[192:193]
    v_rcp_f32 v210, v210
    v_rcp_f32 v211, v211
    v_pk_mul_f32 v[178:179], v[178:179], v[194:195]
    v_rcp_f32 v212, v212
    v_rcp_f32 v213, v213
    v_pk_mul_f32 v[180:181], v[180:181], v[196:197]
    v_rcp_f32 v214, v214
    v_rcp_f32 v215, v215
    v_pk_mul_f32 v[182:183], v[182:183], v[198:199]
    v_pk_fma_f32 v[184:185], v[208:209], v[176:177], v[184:185]
    v_pk_fma_f32 v[186:187], v[210:211], v[178:179], v[186:187]
    v_pk_fma_f32 v[188:189], v[212:213], v[180:181], v[188:189]
    v_pk_fma_f32 v[190:191], v[214:215], v[182:183], v[190:191]
    v_cvt_pk_bf16_f32 v22, v184, v185
    v_cvt_pk_bf16_f32 v23, v186, v187
    v_cvt_pk_bf16_f32 v24, v188, v189
    v_cvt_pk_bf16_f32 v25, v190, v191
    buffer_store_dwordx4 v[22:25], v21, s[64:67], 0 offen sc0 sc1
    s_endpgm
KM_VF:
    s_lshl_b32 s3, s71, 10
    s_add_u32 s3, s3, 12648448
    v_mov_b32 v2, s3
    v_mov_b32 v3, 0x7ff00000
    v_cmp_eq_u32 vcc, 256, v0
    s_nop 1
    v_cndmask_b32 v2, v3, v2, vcc
    v_cndmask_b32 v3, 0, 1, vcc
    ds_read_b64_tr_b16 v[72:73], v8 offset:4096
    ds_read_b64_tr_b16 v[74:75], v8 offset:5120
    s_waitcnt vmcnt(7) lgkmcnt(8)
    v_mfma_f32_32x32x16_bf16 v[112:127], v[56:59], v[192:195], v[112:127]
    buffer_load_dword v53, v2, s[56:59], 0 offen offset:256 sc1
    ds_read_b64_tr_b16 v[76:77], v9 offset:4096
    ds_read_b64_tr_b16 v[78:79], v9 offset:5120
    s_waitcnt lgkmcnt(8)
    v_mfma_f32_32x32x16_bf16 v[128:143], v[60:63], v[192:195], v[128:143]
    s_mul_i32 s25, s70, 65536
    s_add_u32 s25, s25, s23
    s_xor_b32 s83, s73, 2
    s_mul_i32 s83, s83, s9
    s_add_u32 s83, s83, s8
    s_add_u32 m0, s25, 32768
    s_add_u32 s3, s83, 0
    buffer_load_dwordx4 v4, s[36:39], s3 offen lds
    ds_read_b64_tr_b16 v[56:57], v8 offset:6144
    ds_read_b64_tr_b16 v[58:59], v8 offset:7168
    s_waitcnt vmcnt(8) lgkmcnt(8)
    v_mfma_f32_32x32x16_bf16 v[112:127], v[64:67], v[196:199], v[112:127]
    ds_read_b64_tr_b16 v[60:61], v9 offset:6144
    ds_read_b64_tr_b16 v[62:63], v9 offset:7168
    s_waitcnt lgkmcnt(8)
    v_mfma_f32_32x32x16_bf16 v[128:143], v[68:71], v[196:199], v[128:143]
    s_add_u32 m0, s25, 33792
    s_add_u32 s3, s83, 7168
    buffer_load_dwordx4 v4, s[36:39], s3 offen lds
    s_mul_i32 s26, s70, 98304
    s_add_u32 s26, s26, 16384
    v_add_u32 v8, s26, v7
    v_xor_b32 v9, 64, v8
    ds_read_b64_tr_b16 v[64:65], v8 offset:0
    ds_read_b64_tr_b16 v[66:67], v8 offset:1024
    s_waitcnt vmcnt(8) lgkmcnt(8)
    v_mfma_f32_32x32x16_bf16 v[112:127], v[72:75], v[200:203], v[112:127]
    s_add_u32 m0, s25, 34816
    s_add_u32 s3, s83, 14336
    buffer_load_dwordx4 v4, s[36:39], s3 offen lds
    ds_read_b64_tr_b16 v[68:69], v9 offset:0
    ds_read_b64_tr_b16 v[70:71], v9 offset:1024
    s_waitcnt lgkmcnt(8)
    v_mfma_f32_32x32x16_bf16 v[128:143], v[76:79], v[200:203], v[128:143]
    ds_read_b64_tr_b16 v[72:73], v8 offset:2048
    ds_read_b64_tr_b16 v[74:75], v8 offset:3072
    s_waitcnt vmcnt(8) lgkmcnt(8)
    v_mfma_f32_32x32x16_bf16 v[112:127], v[56:59], v[204:207], v[112:127]
    s_add_u32 m0, s25, 35840
    s_add_u32 s3, s83, 21504
    buffer_load_dwordx4 v4, s[36:39], s3 offen lds
    ds_read_b64_tr_b16 v[76:77], v9 offset:2048
    ds_read_b64_tr_b16 v[78:79], v9 offset:3072
    s_waitcnt lgkmcnt(8)
    v_mfma_f32_32x32x16_bf16 v[128:143], v[60:63], v[204:207], v[128:143]
    s_waitcnt vmcnt(4)
    v_lshrrev_b32 v53, 3, v53
    v_cmp_gt_u32 vcc, v3, v53
    s_cbranch_vccnz R_P2F
B_P2F:
    s_barrier
    ds_read_b64_tr_b16 v[56:57], v8 offset:4096
    ds_read_b64_tr_b16 v[58:59], v8 offset:5120
    s_waitcnt lgkmcnt(8)
    v_mfma_f32_32x32x16_bf16 v[112:127], v[64:67], v[208:211], v[112:127]
    s_mul_i32 s25, s70, -81920
    s_add_u32 s25, s25, s23
    s_xor_b32 s83, s73, 3
    s_mul_i32 s83, s83, s9
    s_add_u32 s83, s83, s8
    s_add_u32 m0, s25, 81920
    s_add_u32 s3, s83, 0
    buffer_load_dwordx4 v4, s[36:39], s3 offen lds
    s_add_u32 m0, s25, 82944
    s_add_u32 s3, s83, 7168
    buffer_load_dwordx4 v4, s[36:39], s3 offen lds
    ds_read_b64_tr_b16 v[60:61], v9 offset:4096
    ds_read_b64_tr_b16 v[62:63], v9 offset:5120
    s_waitcnt lgkmcnt(8)
    v_mfma_f32_32x32x16_bf16 v[128:143], v[68:71], v[208:211], v[128:143]
    s_add_u32 m0, s25, 83968
    s_add_u32 s3, s83, 14336
    buffer_load_dwordx4 v4, s[36:39], s3 offen lds
    ds_read_b64_tr_b16 v[64:65], v8 offset:6144
    ds_read_b64_tr_b16 v[66:67], v8 offset:7168
    s_waitcnt lgkmcnt(8)
    v_mfma_f32_32x32x16_bf16 v[112:127], v[72:75], v[212:215], v[112:127]
    s_add_u32 m0, s25, 84992
    s_add_u32 s3, s83, 21504
    buffer_load_dwordx4 v4, s[36:39], s3 offen lds
    s_xor_b32 s84, s73, 0
    s_mul_i32 s84, s84, s17
    s_add_u32 s84, s84, s16
    buffer_load_dwordx4 v[224:227], v1, s[56:59], s84 offen offset:0 sc1
    ds_read_b64_tr_b16 v[68:69], v9 offset:6144
    ds_read_b64_tr_b16 v[70:71], v9 offset:7168
    s_waitcnt lgkmcnt(8)
    v_mfma_f32_32x32x16_bf16 v[128:143], v[76:79], v[212:215], v[128:143]
    buffer_load_dwordx4 v[228:231], v1, s[56:59], s84 offen offset:1024 sc1
    s_waitcnt lgkmcnt(6)
    v_mfma_f32_32x32x16_bf16 v[112:127], v[56:59], v[216:219], v[112:127]
    buffer_load_dwordx4 v[232:235], v1, s[56:59], s84 offen offset:2048 sc1
    buffer_load_dwordx4 v[236:239], v1, s[56:59], s84 offen offset:3072 sc1
    s_waitcnt lgkmcnt(4)
    v_mfma_f32_32x32x16_bf16 v[128:143], v[60:63], v[216:219], v[128:143]
    s_xor_b32 s84, s73, 1
    s_mul_i32 s84, s84, s17
    s_add_u32 s84, s84, s16
    buffer_load_dwordx4 v[240:243], v1, s[56:59], s84 offen offset:0 sc1
    s_waitcnt lgkmcnt(2)
    v_mfma_f32_32x32x16_bf16 v[112:127], v[64:67], v[220:223], v[112:127]
    buffer_load_dwordx4 v[244:247], v1, s[56:59], s84 offen offset:1024 sc1
    buffer_load_dwordx4 v[248:251], v1, s[56:59], s84 offen offset:2048 sc1
    s_waitcnt lgkmcnt(0)
    v_mfma_f32_32x32x16_bf16 v[128:143], v[68:71], v[220:223], v[128:143]
    buffer_load_dwordx4 v[252:255], v1, s[56:59], s84 offen offset:3072 sc1
    s_barrier
    v_add_u32 v32, 49152, v7
    v_xor_b32 v33, 64, v32
    v_add_u32 v34, 147456, v7
    v_xor_b32 v35, 64, v34
    s_setprio 2
    ds_read_b64_tr_b16 v[56:57], v32 offset:0
    ds_read_b64_tr_b16 v[58:59], v32 offset:1024
    ds_read_b64_tr_b16 v[60:61], v33 offset:0
    ds_read_b64_tr_b16 v[62:63], v33 offset:1024
    ds_read_b64_tr_b16 v[64:65], v32 offset:2048
    ds_read_b64_tr_b16 v[66:67], v32 offset:3072
    ds_read_b64_tr_b16 v[68:69], v33 offset:2048
    ds_read_b64_tr_b16 v[70:71], v33 offset:3072
    ds_read_b64_tr_b16 v[176:177], v32 offset:4096
    ds_read_b64_tr_b16 v[178:179], v32 offset:5120
    ds_read_b64_tr_b16 v[180:181], v33 offset:4096
    ds_read_b64_tr_b16 v[182:183], v33 offset:5120
    s_waitcnt vmcnt(7) lgkmcnt(10)
    v_mfma_f32_32x32x16_bf16 v[112:127], v[56:59], v[224:227], v[112:127]
    s_xor_b32 s84, s73, 2
    s_mul_i32 s84, s84, s17
    s_add_u32 s84, s84, s16
    buffer_load_dwordx4 v[144:147], v1, s[56:59], s84 offen offset:0 sc1
    ds_read_b64_tr_b16 v[184:185], v32 offset:6144
    ds_read_b64_tr_b16 v[186:187], v32 offset:7168
    ds_read_b64_tr_b16 v[188:189], v33 offset:6144
    ds_read_b64_tr_b16 v[190:191], v33 offset:7168
    s_waitcnt lgkmcnt(12)
    v_mfma_f32_32x32x16_bf16 v[128:143], v[60:63], v[224:227], v[128:143]
    buffer_load_dwordx4 v[148:151], v1, s[56:59], s84 offen offset:1024 sc1
    ds_read_b64_tr_b16 v[192:193], v34 offset:0
    ds_read_b64_tr_b16 v[194:195], v34 offset:1024
    ds_read_b64_tr_b16 v[196:197], v35 offset:0
    ds_read_b64_tr_b16 v[198:199], v35 offset:1024
    s_waitcnt vmcnt(8) lgkmcnt(14)
    v_mfma_f32_32x32x16_bf16 v[112:127], v[64:67], v[228:231], v[112:127]
    buffer_load_dwordx4 v[152:155], v1, s[56:59], s84 offen offset:2048 sc1
    ds_read_b64_tr_b16 v[200:201], v34 offset:2048
    ds_read_b64_tr_b16 v[202:203], v34 offset:3072
    ds_read_b64_tr_b16 v[204:205], v35 offset:2048
    ds_read_b64_tr_b16 v[206:207], v35 offset:3072
    s_waitcnt lgkmcnt(15)
    v_mfma_f32_32x32x16_bf16 v[128:143], v[68:71], v[228:231], v[128:143]
    buffer_load_dwordx4 v[156:159], v1, s[56:59], s84 offen offset:3072 sc1
    ds_read_b64_tr_b16 v[208:209], v34 offset:4096
    ds_read_b64_tr_b16 v[210:211], v34 offset:5120
    ds_read_b64_tr_b16 v[212:213], v35 offset:4096
    ds_read_b64_tr_b16 v[214:215], v35 offset:5120
    s_waitcnt vmcnt(9) lgkmcnt(15)
    v_mfma_f32_32x32x16_bf16 v[112:127], v[176:179], v[232:235], v[112:127]
    ds_read_b64_tr_b16 v[216:217], v34 offset:6144
    ds_read_b64_tr_b16 v[218:219], v34 offset:7168
    ds_read_b64_tr_b16 v[220:221], v35 offset:6144
    ds_read_b64_tr_b16 v[222:223], v35 offset:7168
    s_setprio 0
    s_waitcnt lgkmcnt(15)
    v_mfma_f32_32x32x16_bf16 v[128:143], v[180:183], v[232:235], v[128:143]
    s_xor_b32 s84, s73, 3
    s_mul_i32 s84, s84, s17
    s_add_u32 s84, s84, s16
    buffer_load_dwordx4 v[160:163], v1, s[56:59], s84 offen offset:0 sc1
    s_waitcnt vmcnt(9) lgkmcnt(15)
    v_mfma_f32_32x32x16_bf16 v[112:127], v[184:187], v[236:239], v[112:127]
    buffer_load_dwordx4 v[164:167], v1, s[56:59], s84 offen offset:1024 sc1
    s_waitcnt lgkmcnt(15)
    v_mfma_f32_32x32x16_bf16 v[128:143], v[188:191], v[236:239], v[128:143]
    buffer_load_dwordx4 v[168:171], v1, s[56:59], s84 offen offset:2048 sc1
    s_waitcnt vmcnt(10) lgkmcnt(14)
    v_mfma_f32_32x32x16_bf16 v[112:127], v[192:195], v[240:243], v[112:127]
    s_waitcnt lgkmcnt(12)
    v_mfma_f32_32x32x16_bf16 v[128:143], v[196:199], v[240:243], v[128:143]
    buffer_load_dwordx4 v[172:175], v1, s[56:59], s84 offen offset:3072 sc1
    s_waitcnt vmcnt(10) lgkmcnt(10)
    v_mfma_f32_32x32x16_bf16 v[112:127], v[200:203], v[244:247], v[112:127]
    buffer_load_dwordx4 v[22:25], v21, s[28:31], 0 offen
    s_waitcnt lgkmcnt(8)
    v_mfma_f32_32x32x16_bf16 v[128:143], v[204:207], v[244:247], v[128:143]
    s_waitcnt vmcnt(10) lgkmcnt(6)
    v_mfma_f32_32x32x16_bf16 v[112:127], v[208:211], v[248:251], v[112:127]
    s_waitcnt lgkmcnt(4)
    v_mfma_f32_32x32x16_bf16 v[128:143], v[212:215], v[248:251], v[128:143]
    s_waitcnt vmcnt(9) lgkmcnt(2)
    v_mfma_f32_32x32x16_bf16 v[112:127], v[216:219], v[252:255], v[112:127]
    s_waitcnt lgkmcnt(0)
    v_mfma_f32_32x32x16_bf16 v[128:143], v[220:223], v[252:255], v[128:143]
    s_barrier
    v_add_u32 v36, 98304, v7
    v_xor_b32 v37, 64, v36
    v_add_u32 v38, 0, v7
    v_xor_b32 v39, 64, v38
    s_bitcmp1_b32 s68, 1
    s_cselect_b32 s26, 9, 3
    s_lshl_b32 s26, s26, 14
    v_add_u32 v15, s26, v20
    v_xor_b32 v16, 32, v15
    v_xor_b32 v17, 64, v15
    v_xor_b32 v18, 96, v15
    s_setprio 2
    ds_read_b64_tr_b16 v[56:57], v36 offset:0
    ds_read_b64_tr_b16 v[58:59], v36 offset:1024
    ds_read_b64_tr_b16 v[60:61], v36 offset:2048
    ds_read_b64_tr_b16 v[62:63], v36 offset:3072
    ds_read_b64_tr_b16 v[64:65], v36 offset:4096
    ds_read_b64_tr_b16 v[66:67], v36 offset:5120
    ds_read_b64_tr_b16 v[68:69], v36 offset:6144
    ds_read_b64_tr_b16 v[70:71], v36 offset:7168
    ds_read_b64_tr_b16 v[176:177], v38 offset:0
    ds_read_b64_tr_b16 v[178:179], v38 offset:1024
    ds_read_b64_tr_b16 v[180:181], v38 offset:2048
    ds_read_b64_tr_b16 v[182:183], v38 offset:3072
    s_waitcnt vmcnt(8) lgkmcnt(10)
    v_mfma_f32_32x32x16_bf16 v[112:127], v[56:59], v[144:147], v[112:127]
    ds_read_b64_tr_b16 v[184:185], v38 offset:4096
    ds_read_b64_tr_b16 v[186:187], v38 offset:5120
    ds_read_b64_tr_b16 v[188:189], v38 offset:6144
    ds_read_b64_tr_b16 v[190:191], v38 offset:7168
    s_waitcnt vmcnt(7) lgkmcnt(12)
    v_mfma_f32_32x32x16_bf16 v[112:127], v[60:63], v[148:151], v[112:127]
    ds_read_b64_tr_b16 v[192:193], v37 offset:0
    ds_read_b64_tr_b16 v[194:195], v37 offset:1024
    ds_read_b64_tr_b16 v[196:197], v37 offset:2048
    ds_read_b64_tr_b16 v[198:199], v37 offset:3072
    s_waitcnt vmcnt(6) lgkmcnt(14)
    v_mfma_f32_32x32x16_bf16 v[112:127], v[64:67], v[152:155], v[112:127]
    ds_read_b64_tr_b16 v[200:201], v37 offset:4096
    ds_read_b64_tr_b16 v[202:203], v37 offset:5120
    ds_read_b64_tr_b16 v[204:205], v37 offset:6144
    ds_read_b64_tr_b16 v[206:207], v37 offset:7168
    s_waitcnt vmcnt(5) lgkmcnt(15)
    v_mfma_f32_32x32x16_bf16 v[112:127], v[68:71], v[156:159], v[112:127]
    ds_read_b64_tr_b16 v[208:209], v39 offset:0
    ds_read_b64_tr_b16 v[210:211], v39 offset:1024
    ds_read_b64_tr_b16 v[212:213], v39 offset:2048
    ds_read_b64_tr_b16 v[214:215], v39 offset:3072
    s_waitcnt vmcnt(4) lgkmcnt(15)
    v_mfma_f32_32x32x16_bf16 v[112:127], v[176:179], v[160:163], v[112:127]
    ds_read_b64_tr_b16 v[216:217], v39 offset:4096
    ds_read_b64_tr_b16 v[218:219], v39 offset:5120
    ds_read_b64_tr_b16 v[220:221], v39 offset:6144
    ds_read_b64_tr_b16 v[222:223], v39 offset:7168
    s_setprio 0
    s_waitcnt vmcnt(3) lgkmcnt(15)
    v_mfma_f32_32x32x16_bf16 v[112:127], v[180:183], v[164:167], v[112:127]
    s_waitcnt vmcnt(2) lgkmcnt(15)
    v_mfma_f32_32x32x16_bf16 v[112:127], v[184:187], v[168:171], v[112:127]
    s_waitcnt vmcnt(1) lgkmcnt(15)
    v_mfma_f32_32x32x16_bf16 v[112:127], v[188:191], v[172:175], v[112:127]
    s_waitcnt lgkmcnt(14)
    v_mfma_f32_32x32x16_bf16 v[128:143], v[192:195], v[144:147], v[128:143]
    s_waitcnt lgkmcnt(12)
    v_mfma_f32_32x32x16_bf16 v[128:143], v[196:199], v[148:151], v[128:143]
    s_waitcnt lgkmcnt(10)
    v_mfma_f32_32x32x16_bf16 v[128:143], v[200:203], v[152:155], v[128:143]
    s_nop 5
    ds_write_b128 v15, v[112:115] offset:0
    s_waitcnt lgkmcnt(9)
    v_mfma_f32_32x32x16_bf16 v[128:143], v[204:207], v[156:159], v[128:143]
    ds_write_b128 v16, v[116:119] offset:0
    s_waitcnt lgkmcnt(8)
    v_mfma_f32_32x32x16_bf16 v[128:143], v[208:211], v[160:163], v[128:143]
    ds_write_b128 v17, v[120:123] offset:0
    s_waitcnt lgkmcnt(7)
    v_mfma_f32_32x32x16_bf16 v[128:143], v[212:215], v[164:167], v[128:143]
    ds_write_b128 v18, v[124:127] offset:0
    s_waitcnt lgkmcnt(6)
    v_mfma_f32_32x32x16_bf16 v[128:143], v[216:219], v[168:171], v[128:143]
    s_waitcnt lgkmcnt(4)
    v_mfma_f32_32x32x16_bf16 v[128:143], v[220:223], v[172:175], v[128:143]
    v_add_u32 v32, 16384, v19
    v_xor_b32 v33, 16, v32
    v_add_u32 v34, 114688, v19
    v_xor_b32 v35, 16, v34
    v_add_u32 v36, 49152, v19
    v_xor_b32 v37, 16, v36
    v_add_u32 v38, 147456, v19
    v_xor_b32 v39, 16, v38
    s_nop 3
    ds_write_b128 v15, v[128:131] offset:128
    ds_write_b128 v16, v[132:135] offset:128
    ds_write_b128 v17, v[136:139] offset:128
    ds_write_b128 v18, v[140:143] offset:128
    v_add_u32 v40, 131072, v19
    v_xor_b32 v41, 16, v40
    v_add_u32 v42, 65536, v19
    v_xor_b32 v43, 16, v42
    v_mov_b32 v30, 0xbfb8aa3b
    v_mov_b32 v31, 1.0
    s_waitcnt vmcnt(0)
    v_lshlrev_b32 v184, 16, v22
    v_and_b32 v185, 0xffff0000, v22
    v_lshlrev_b32 v186, 16, v23
    v_and_b32 v187, 0xffff0000, v23
    v_lshlrev_b32 v188, 16, v24
    v_and_b32 v189, 0xffff0000, v24
    v_lshlrev_b32 v190, 16, v25
    v_and_b32 v191, 0xffff0000, v25
    s_waitcnt lgkmcnt(0)
    s_barrier
    ds_read_b128 v[176:179], v32
    ds_read_b128 v[180:183], v33
    ds_read_b128 v[224:227], v34
    ds_read_b128 v[228:231], v35
    ds_read_b128 v[208:211], v36
    ds_read_b128 v[212:215], v37
    ds_read_b128 v[216:219], v38
    ds_read_b128 v[220:223], v39
    ds_read_b128 v[192:195], v40
    ds_read_b128 v[196:199], v41
    ds_read_b128 v[200:203], v42
    ds_read_b128 v[204:207], v43
    s_waitcnt lgkmcnt(9)
    v_pk_add_f32 v[176:177], v[176:177], v[224:225]
    v_pk_add_f32 v[178:179], v[178:179], v[226:227]
    s_waitcnt lgkmcnt(8)
    v_pk_add_f32 v[180:181], v[180:181], v[228:229]
    v_pk_add_f32 v[182:183], v[182:183], v[230:231]
    s_waitcnt lgkmcnt(5)
    v_pk_add_f32 v[208:209], v[208:209], v[216:217]
    v_pk_add_f32 v[210:211], v[210:211], v[218:219]
    s_waitcnt lgkmcnt(4)
    v_pk_add_f32 v[212:213], v[212:213], v[220:221]
    v_pk_add_f32 v[214:215], v[214:215], v[222:223]
    v_pk_add_f32 v[176:177], v[176:177], v[208:209]
    v_pk_add_f32 v[178:179], v[178:179], v[210:211]
    v_pk_add_f32 v[180:181], v[180:181], v[212:213]
    v_pk_add_f32 v[182:183], v[182:183], v[214:215]
    v_pk_mul_f32 v[208:209], v[176:177], v[30:31] op_sel_hi:[1,0]
    v_pk_mul_f32 v[210:211], v[178:179], v[30:31] op_sel_hi:[1,0]
    v_pk_mul_f32 v[212:213], v[180:181], v[30:31] op_sel_hi:[1,0]
    v_pk_mul_f32 v[214:215], v[182:183], v[30:31] op_sel_hi:[1,0]
    v_exp_f32 v208, v208
    v_exp_f32 v209, v209
    s_waitcnt lgkmcnt(1)
    v_pk_add_f32 v[192:193], v[192:193], v[200:201]
    v_exp_f32 v210, v210
    v_exp_f32 v211, v211
    v_pk_add_f32 v[194:195], v[194:195], v[202:203]
    v_exp_f32 v212, v212
    v_exp_f32 v213, v213
    s_waitcnt lgkmcnt(0)
    v_pk_add_f32 v[196:197], v[196:197], v[204:205]
    v_exp_f32 v214, v214
    v_exp_f32 v215, v215
    v_pk_add_f32 v[198:199], v[198:199], v[206:207]
    v_pk_add_f32 v[208:209], v[208:209], v[30:31] op_sel:[0,1] op_sel_hi:[1,1]
    v_pk_add_f32 v[210:211], v[210:211], v[30:31] op_sel:[0,1] op_sel_hi:[1,1]
    v_pk_add_f32 v[212:213], v[212:213], v[30:31] op_sel:[0,1] op_sel_hi:[1,1]
    v_pk_add_f32 v[214:215], v[214:215], v[30:31] op_sel:[0,1] op_sel_hi:[1,1]
    v_rcp_f32 v208, v208
    v_rcp_f32 v209, v209
    v_pk_mul_f32 v[176:177], v[176:177], v[192:193]
    v_rcp_f32 v210, v210
    v_rcp_f32 v211, v211
    v_pk_mul_f32 v[178:179], v[178:179], v[194:195]
    v_rcp_f32 v212, v212
    v_rcp_f32 v213, v213
    v_pk_mul_f32 v[180:181], v[180:181], v[196:197]
    v_rcp_f32 v214, v214
    v_rcp_f32 v215, v215
    v_pk_mul_f32 v[182:183], v[182:183], v[198:199]
    v_pk_fma_f32 v[184:185], v[208:209], v[176:177], v[184:185]
    v_pk_fma_f32 v[186:187], v[210:211], v[178:179], v[186:187]
    v_pk_fma_f32 v[188:189], v[212:213], v[180:181], v[188:189]
    v_pk_fma_f32 v[190:191], v[214:215], v[182:183], v[190:191]
    v_cvt_pk_bf16_f32 v22, v184, v185
    v_cvt_pk_bf16_f32 v23, v186, v187
    v_cvt_pk_bf16_f32 v24, v188, v189
    v_cvt_pk_bf16_f32 v25, v190, v191
    buffer_store_dwordx4 v[22:25], v21, s[64:67], 0 offen sc0 sc1
    s_endpgm
R_P0F:
    s_mov_b32 s27, 0x8000
L_P0F:
    s_sleep 6
    buffer_load_dword v53, v52, s[56:59], 0 offen offset:0 sc1
    s_waitcnt vmcnt(0)
    v_lshrrev_b32 v53, 3, v53
    v_cmp_gt_u32 vcc, v5, v53
    s_cbranch_vccz B_P0F
    s_sub_u32 s27, s27, 1
    s_cmp_lg_u32 s27, 0
    s_cbranch_scc1 L_P0F
    s_branch B_P0F
R_CFF:
    s_mov_b32 s27, 0x8000
L_CFF:
    s_sleep 16
    v_lshlrev_b32 v53, 6, v0
    buffer_load_dword v53, v53, s[60:63], 0 offen offset:128 sc1
    s_waitcnt vmcnt(0)
    v_cmp_gt_u32 vcc, v52, v53
    s_cbranch_vccz B_CFF
    s_sub_u32 s27, s27, 1
    s_cmp_lg_u32 s27, 0
    s_cbranch_scc1 L_CFF
    s_branch B_CFF
R_P1F:
    s_mov_b32 s27, 0x8000
L_P1F:
    s_sleep 6
    buffer_load_dword v53, v52, s[56:59], 0 offen offset:128 sc1
    s_waitcnt vmcnt(0)
    v_lshrrev_b32 v53, 3, v53
    v_cmp_gt_u32 vcc, v5, v53
    s_cbranch_vccz B_P1F
    s_sub_u32 s27, s27, 1
    s_cmp_lg_u32 s27, 0
    s_cbranch_scc1 L_P1F
    s_branch B_P1F
R_P4F:
    s_mov_b32 s27, 0x8000
L_P4F:
    s_sleep 6
    buffer_load_dword v53, v52, s[56:59], 0 offen offset:512 sc1
    s_waitcnt vmcnt(0)
    v_lshrrev_b32 v53, 3, v53
    v_cmp_gt_u32 vcc, v5, v53
    s_cbranch_vccz B_P4F
    s_sub_u32 s27, s27, 1
    s_cmp_lg_u32 s27, 0
    s_cbranch_scc1 L_P4F
    s_branch B_P4F
R_P3F:
    s_mov_b32 s27, 0x8000
L_P3F:
    s_sleep 6
    buffer_load_dword v53, v52, s[56:59], 0 offen offset:384 sc1
    s_waitcnt vmcnt(0)
    v_lshrrev_b32 v53, 3, v53
    v_cmp_gt_u32 vcc, v5, v53
    s_cbranch_vccz B_P3F
    s_sub_u32 s27, s27, 1
    s_cmp_lg_u32 s27, 0
    s_cbranch_scc1 L_P3F
    s_branch B_P3F
R_P2F:
    s_mov_b32 s27, 0x8000
L_P2F:
    s_sleep 6
    buffer_load_dword v53, v2, s[56:59], 0 offen offset:256 sc1
    s_waitcnt vmcnt(0)
    v_lshrrev_b32 v53, 3, v53
    v_cmp_gt_u32 vcc, v3, v53
    s_cbranch_vccz B_P2F
    s_sub_u32 s27, s27, 1
    s_cmp_lg_u32 s27, 0
    s_cbranch_scc1 L_P2F
    s_branch B_P2F
KM_H:
    v_lshlrev_b32 v46, 2, v32
    v_add_u32 v46, 159744, v46
    s_mov_b32 s60, s22
    s_mov_b32 s61, s23
    s_mov_b32 s62, 256
    s_mov_b32 s63, 0x20000
    s_cmp_lg_u32 s70, 0
    s_cbranch_scc1 KM_BH
    s_mul_i32 s26, s72, 3136
    s_add_u32 s64, s8, s26
    s_addc_u32 s65, s9, 0
    s_sub_u32 s66, 25088, s26
    s_mov_b32 s67, 0x20000
    s_mul_i32 s26, s68, 800
    s_add_u32 m0, s26, 155648
    s_mov_b32 exec_hi, 0x3ffff
    buffer_load_dwordx4 v1, s[64:67], s26 offen lds
    s_add_u32 m0, s26, 160260
    s_nop 0
    buffer_load_dwordx4 v1, s[64:67], s26 offen lds
    s_mov_b32 exec_hi, -1
    s_add_u32 s26, s93, 4096
    s_add_u32 s27, s91, 131072
    buffer_store_dwordx4 v[48:51], v1, s[56:59], s91 offen offset:0 sc0 sc1
    buffer_store_dwordx4 v[48:51], v1, s[56:59], s91 offen offset:1024 sc0 sc1
    buffer_store_dwordx4 v[48:51], v1, s[56:59], s27 offen offset:0 sc0 sc1
    buffer_store_dwordx4 v[48:51], v1, s[56:59], s27 offen offset:1024 sc0 sc1
    buffer_store_dword v48, v52, s[56:59], s93 offen sc0 sc1
    buffer_store_dword v48, v52, s[56:59], s26 offen sc0 sc1
KM_BH:
    s_nop 1
    s_waitcnt lgkmcnt(0) vmcnt(14)
    s_barrier
    v_add_u32 v8, 114688, v7
    ds_read_b64_tr_b16 v[56:57], v8 offset:0
    ds_read_b64_tr_b16 v[58:59], v8 offset:512
    ds_read_b128 v[144:147], v11 offset:0
    ds_read_b64_tr_b16 v[60:61], v8 offset:2048
    ds_read_b64_tr_b16 v[62:63], v8 offset:2560
    ds_read_b128 v[148:151], v12 offset:0
    ds_read_b64_tr_b16 v[64:65], v8 offset:4096
    ds_read_b64_tr_b16 v[66:67], v8 offset:4608
    ds_read_b128 v[152:155], v13 offset:0
    ds_read_b64_tr_b16 v[68:69], v8 offset:6144
    ds_read_b64_tr_b16 v[70:71], v8 offset:6656
    ds_read_b128 v[156:159], v14 offset:0
    v_add_u32 v8, 122880, v7
    ds_read_b64_tr_b16 v[72:73], v8 offset:0
    ds_read_b64_tr_b16 v[74:75], v8 offset:512
    ds_read_b128 v[160:163], v11 offset:16384
    s_waitcnt lgkmcnt(12)
    v_mfma_f32_32x32x16_bf16 v[80:95], v[56:59], v[144:147], 0
    v_add_f32_dpp v44, v44, v44 quad_perm:[1,0,3,2] row_mask:0xf bank_mask:0xf
    v_add_f32_dpp v45, v45, v45 quad_perm:[1,0,3,2] row_mask:0xf bank_mask:0xf
    s_nop 0
    v_add_f32_dpp v44, v44, v44 quad_perm:[2,3,0,1] row_mask:0xf bank_mask:0xf
    s_setprio 1
    ds_read_b64_tr_b16 v[76:77], v8 offset:2048
    ds_read_b64_tr_b16 v[78:79], v8 offset:2560
    ds_read_b128 v[164:167], v12 offset:16384
    s_waitcnt lgkmcnt(12)
    v_mfma_f32_32x32x16_bf16 v[80:95], v[60:63], v[148:151], v[80:95]
    v_add_f32_dpp v45, v45, v45 quad_perm:[2,3,0,1] row_mask:0xf bank_mask:0xf
    v_add_f32_dpp v44, v44, v44 row_half_mirror row_mask:0xf bank_mask:0xf
    s_nop 0
    v_add_f32_dpp v45, v45, v45 row_half_mirror row_mask:0xf bank_mask:0xf
    v_mul_f32 v44, 0x3b124925, v44
    ds_read_b64_tr_b16 v[56:57], v8 offset:4096
    ds_read_b64_tr_b16 v[58:59], v8 offset:4608
    ds_read_b128 v[168:171], v13 offset:16384
    s_waitcnt lgkmcnt(12)
    v_mfma_f32_32x32x16_bf16 v[80:95], v[64:67], v[152:155], v[80:95]
    v_mul_f32 v45, 0x3b124925, v45
    v_fma_f32 v44, -v38, v38, v44
    v_fma_f32 v45, -v39, v39, v45
    s_setprio 0
    ds_read_b64_tr_b16 v[60:61], v8 offset:6144
    ds_read_b64_tr_b16 v[62:63], v8 offset:6656
    ds_read_b128 v[172:175], v14 offset:16384
    s_waitcnt lgkmcnt(12)
    v_mfma_f32_32x32x16_bf16 v[80:95], v[68:71], v[156:159], v[80:95]
    s_waitcnt lgkmcnt(0) vmcnt(10)
    s_barrier
    v_mfma_f32_32x32x16_bf16 v[80:95], v[72:75], v[160:163], v[80:95]
    v_max_f32 v44, 0, v44
    v_max_f32 v45, 0, v45
    v_cvt_pk_bf16_f32 v45, v44, v45
    v_lshlrev_b32 v44, 16, v45
    s_setprio 3
    v_add_u32 v8, 131072, v7
    ds_read_b64_tr_b16 v[64:65], v8 offset:0
    ds_read_b64_tr_b16 v[66:67], v8 offset:512
    ds_read_b64_tr_b16 v[68:69], v8 offset:2048
    ds_read_b64_tr_b16 v[70:71], v8 offset:2560
    ds_read_b128 v[176:179], v11 offset:32768
    ds_read_b128 v[180:183], v12 offset:32768
    s_add_u32 m0, s75, 0
    v_mfma_f32_32x32x16_bf16 v[80:95], v[76:79], v[164:167], v[80:95]
    v_and_b32 v45, 0xffff0000, v45
    v_add_f32 v44, 0x3727c5ac, v44
    v_add_f32 v45, 0x3727c5ac, v45
    buffer_load_dwordx4 v4, s[32:35], s88 offen lds
    ds_read_b64_tr_b16 v[72:73], v8 offset:4096
    ds_read_b64_tr_b16 v[74:75], v8 offset:4608
    ds_read_b128 v[184:187], v13 offset:32768
    s_add_u32 m0, s75, 8192
    v_mfma_f32_32x32x16_bf16 v[80:95], v[56:59], v[168:171], v[80:95]
    v_cvt_pk_bf16_f32 v45, v44, v45
    v_lshlrev_b32 v44, 16, v45
    v_and_b32 v45, 0xffff0000, v45
    s_setprio 2
    buffer_load_dwordx4 v4, s[32:35], s89 offen lds
    ds_read_b64_tr_b16 v[76:77], v8 offset:6144
    ds_read_b64_tr_b16 v[78:79], v8 offset:6656
    ds_read_b128 v[188:191], v14 offset:32768
    s_add_u32 m0, s75, 16384
    v_mfma_f32_32x32x16_bf16 v[80:95], v[60:63], v[172:175], v[80:95]
    v_sqrt_f32 v44, v44
    v_sqrt_f32 v45, v45
    buffer_load_dwordx4 v4, s[40:43], s83 offen lds
    v_add_u32 v8, 139264, v7
    ds_read_b64_tr_b16 v[56:57], v8 offset:0
    ds_read_b64_tr_b16 v[58:59], v8 offset:512
    ds_read_b128 v[192:195], v11 offset:49152
    s_waitcnt lgkmcnt(10)
    v_mfma_f32_32x32x16_bf16 v[80:95], v[64:67], v[176:179], v[80:95]
    v_cvt_pk_bf16_f32 v45, v44, v45
    v_lshlrev_b32 v44, 16, v45
    v_and_b32 v45, 0xffff0000, v45
    ds_write_b32 v46, v44
    s_setprio 1
    s_and_b32 s3, s2, 1
    s_lshl_b32 s3, s3, 6
    v_lshlrev_b32 v52, 20, v0
    v_add_u32 v52, s3, v52
    v_mov_b32 v53, 1
    ds_read_b64_tr_b16 v[60:61], v8 offset:2048
    ds_read_b64_tr_b16 v[62:63], v8 offset:2560
    ds_read_b128 v[196:199], v12 offset:49152
    s_add_u32 m0, s75, 24576
    s_waitcnt lgkmcnt(13)
    v_mfma_f32_32x32x16_bf16 v[80:95], v[68:71], v[180:183], v[80:95]
    v_xor_b32 v46, 256, v46
    ds_write_b32 v46, v45
    buffer_load_dwordx4 v4, s[40:43], s84 offen lds
    ds_read_b64_tr_b16 v[64:65], v8 offset:4096
    ds_read_b64_tr_b16 v[66:67], v8 offset:4608
    ds_read_b128 v[200:203], v13 offset:49152
    s_waitcnt lgkmcnt(14)
    v_mfma_f32_32x32x16_bf16 v[80:95], v[72:75], v[184:187], v[80:95]
    s_setprio 0
    ds_read_b64_tr_b16 v[68:69], v8 offset:6144
    ds_read_b64_tr_b16 v[70:71], v8 offset:6656
    ds_read_b128 v[204:207], v14 offset:49152
    s_waitcnt lgkmcnt(14)
    v_mfma_f32_32x32x16_bf16 v[80:95], v[76:79], v[188:191], v[80:95]
    s_waitcnt lgkmcnt(0) vmcnt(10)
    s_barrier
    v_mfma_f32_32x32x16_bf16 v[80:95], v[56:59], v[192:195], v[80:95]
    ds_read_b64_tr_b16 v[18:19], v47 offset:0
    ds_read_b64_tr_b16 v[20:21], v47 offset:448
    ds_read_b64_tr_b16 v[22:23], v47 offset:896
    ds_read_b64_tr_b16 v[24:25], v47 offset:1344
    s_setprio 1
    v_add_u32 v8, 147456, v7
    ds_read_b64_tr_b16 v[72:73], v8 offset:0
    ds_read_b64_tr_b16 v[74:75], v8 offset:512
    ds_read_b64_tr_b16 v[76:77], v8 offset:2048
    ds_read_b64_tr_b16 v[78:79], v8 offset:2560
    v_add_u32 v11, 0x10000, v11
    v_add_u32 v12, 0x10000, v12
    v_add_u32 v13, 0x10000, v13
    v_add_u32 v14, 0x10000, v14
    ds_read_b128 v[208:211], v11 offset:0
    ds_read_b128 v[212:215], v12 offset:0
    s_add_u32 m0, s75, 32768
    v_mfma_f32_32x32x16_bf16 v[80:95], v[60:63], v[196:199], v[80:95]
    buffer_load_dwordx4 v4, s[40:43], s85 offen lds
    ds_read_b64_tr_b16 v[56:57], v8 offset:4096
    ds_read_b64_tr_b16 v[58:59], v8 offset:4608
    ds_read_b128 v[216:219], v13 offset:0
    v_mfma_f32_32x32x16_bf16 v[80:95], v[64:67], v[200:203], v[80:95]
    s_setprio 0
    ds_read_b64_tr_b16 v[60:61], v8 offset:6144
    ds_read_b64_tr_b16 v[62:63], v8 offset:6656
    ds_read_b128 v[220:223], v14 offset:0
    v_mfma_f32_32x32x16_bf16 v[80:95], v[68:71], v[204:207], v[80:95]
    s_waitcnt lgkmcnt(0) vmcnt(3)
    s_barrier
    v_mfma_f32_32x32x16_bf16 v[80:95], v[72:75], v[208:211], v[80:95]
    v_cndmask_b32 v24, v24, 0, s[100:101]
    v_cndmask_b32 v25, v25, 0, s[100:101]
    s_and_b32 s24, s72, 3
    s_add_u32 s24, s24, 4
    s_and_b32 s26, s71, 3
    s_setprio 3
    v_add_u32 v8, 0, v7
    ds_read_b64_tr_b16 v[64:65], v8 offset:0
    ds_read_b64_tr_b16 v[66:67], v8 offset:512
    ds_read_b64_tr_b16 v[68:69], v8 offset:2048
    ds_read_b64_tr_b16 v[70:71], v8 offset:2560
    ds_read_b128 v[224:227], v11 offset:16384
    ds_read_b128 v[228:231], v12 offset:16384
    s_add_u32 m0, s75, 40960
    v_mfma_f32_32x32x16_bf16 v[80:95], v[76:79], v[212:215], v[80:95]
    s_mul_i32 s26, s26, 2
    s_add_u32 s26, s26, s24
    s_cmp_ge_u32 s26, 7
    s_cselect_b32 s27, 7, 0
    s_sub_u32 s26, s26, s27
    s_lshl_b32 s26, s26, 7
    s_add_u32 s32, s18, s26
    s_addc_u32 s33, s19, 0
    s_sub_u32 s34, 1605632, s26
    buffer_load_dwordx4 v4, s[40:43], s86 offen lds
    ds_read_b64_tr_b16 v[72:73], v8 offset:4096
    ds_read_b64_tr_b16 v[74:75], v8 offset:4608
    ds_read_b128 v[232:235], v13 offset:16384
    v_mfma_f32_32x32x16_bf16 v[80:95], v[56:59], v[216:219], v[80:95]
    s_mov_b32 s35, 0x20000
    s_add_u32 s36, s10, s26
    s_addc_u32 s37, s11, 0
    s_sub_u32 s38, 401408, s26
    s_mov_b32 s39, 0x20000
    s_lshr_b32 s27, s72, 2
    s_lshl_b32 s73, s71, 1
    s_add_u32 s73, s73, s27
    s_setprio 2
    ds_read_b64_tr_b16 v[76:77], v8 offset:6144
    ds_read_b64_tr_b16 v[78:79], v8 offset:6656
    ds_read_b128 v[236:239], v14 offset:16384
    s_add_u32 m0, s75, 114688
    v_mfma_f32_32x32x16_bf16 v[80:95], v[60:63], v[220:223], v[80:95]
    s_mul_i32 s27, s73, 57344
    s_add_u32 s26, s26, s27
    s_add_u32 s28, s4, s26
    s_addc_u32 s29, s5, 0
    s_sub_u32 s30, 1835008, s26
    s_mov_b32 s31, 0x20000
    s_add_u32 s64, s20, s26
    s_addc_u32 s65, s21, 0
    s_sub_u32 s66, 1835008, s26
    buffer_load_dwordx4 v4, s[40:43], s87 offen lds
    v_add_u32 v8, 8192, v7
    ds_read_b64_tr_b16 v[56:57], v8 offset:0
    ds_read_b64_tr_b16 v[58:59], v8 offset:512
    ds_read_b128 v[240:243], v11 offset:32768
    s_waitcnt lgkmcnt(10)
    v_mfma_f32_32x32x16_bf16 v[80:95], v[64:67], v[224:227], v[80:95]
    s_mov_b32 s67, 0x20000
    s_lshr_b32 s22, s68, 1
    s_and_b32 s26, s68, 1
    s_lshl_b32 s73, s73, 1
    s_add_u32 s73, s73, s26
    s_mul_i32 s73, s73, 147456
    s_lshl_b32 s23, s69, 12
    s_setprio 1
    ds_read_b64_tr_b16 v[60:61], v8 offset:2048
    ds_read_b64_tr_b16 v[62:63], v8 offset:2560
    ds_read_b128 v[244:247], v12 offset:32768
    s_add_u32 m0, s75, 122880
    s_waitcnt lgkmcnt(12)
    v_mfma_f32_32x32x16_bf16 v[80:95], v[68:71], v[228:231], v[80:95]
    s_mul_i32 s26, s26, 28672
    v_bfe_u32 v30, v0, 3, 3
    v_and_b32 v31, 7, v0
    v_bfe_u32 v54, v0, 4, 1
    buffer_load_dwordx4 v4, s[40:43], s88 offen lds
    ds_read_b64_tr_b16 v[64:65], v8 offset:4096
    ds_read_b64_tr_b16 v[66:67], v8 offset:4608
    ds_read_b128 v[248:251], v13 offset:32768
    s_waitcnt lgkmcnt(12)
    v_mfma_f32_32x32x16_bf16 v[80:95], v[72:75], v[232:235], v[80:95]
    v_lshlrev_b32 v54, 2, v54
    v_xor_b32 v31, v31, v54
    v_mul_u32_u24 v30, 896, v30
    s_setprio 0
    ds_read_b64_tr_b16 v[68:69], v8 offset:6144
    ds_read_b64_tr_b16 v[70:71], v8 offset:6656
    ds_read_b128 v[252:255], v14 offset:32768
    s_waitcnt lgkmcnt(9)
    v_mfma_f32_32x32x16_bf16 v[80:95], v[76:79], v[236:239], v[80:95]
    s_waitcnt vmcnt(4) lgkmcnt(0)
    s_barrier
    v_mfma_f32_32x32x16_bf16 v[80:95], v[56:59], v[240:243], v[80:95]
    v_lshl_add_u32 v30, v31, 4, v30
    v_add_u32 v54, s26, v30
    s_mul_i32 s14, s22, 192
    s_add_u32 s14, s14, 256
    s_lshl_b32 s15, s22, 6
    s_mul_i32 s6, s14, 896
    s_setprio 3
    v_add_u32 v8, 16384, v7
    ds_read_b64_tr_b16 v[72:73], v8 offset:0
    ds_read_b64_tr_b16 v[74:75], v8 offset:512
    ds_read_b64_tr_b16 v[76:77], v8 offset:2048
    ds_read_b64_tr_b16 v[78:79], v8 offset:2560
    s_add_u32 m0, s75, 131072
    v_mfma_f32_32x32x16_bf16 v[80:95], v[60:63], v[244:247], v[80:95]
    s_lshl_b32 s14, s14, 6
    s_add_u32 s14, s14, s73
    s_mul_i32 s7, s15, 896
    s_lshl_b32 s15, s15, 6
    s_add_u32 s15, s15, s73
    s_and_b32 s26, s22, 1
    s_mul_i32 s27, s26, 192
    buffer_load_dwordx4 v4, s[40:43], s89 offen lds
    ds_read_b64_tr_b16 v[56:57], v8 offset:4096
    ds_read_b64_tr_b16 v[58:59], v8 offset:4608
    v_mfma_f32_32x32x16_bf16 v[80:95], v[64:67], v[248:251], v[80:95]
    s_add_u32 s27, s27, 384
    s_mul_i32 s8, s27, 896
    s_lshl_b32 s16, s27, 6
    s_mul_i32 s27, s26, 50176
    s_lshl_b32 s26, s26, 12
    s_add_u32 s26, s26, 114688
    s_mov_b32 s9, 344064
    s_setprio 2
    ds_read_b64_tr_b16 v[60:61], v8 offset:6144
    ds_read_b64_tr_b16 v[62:63], v8 offset:6656
    s_waitcnt lgkmcnt(6)
    v_mfma_f32_32x32x16_bf16 v[80:95], v[68:71], v[252:255], v[80:95]
    s_movk_i32 s17, 24576
    s_cmp_eq_u32 s70, 0
    s_cselect_b32 s8, s27, s8
    s_cselect_b32 s16, s26, s16
    s_cselect_b32 s9, 100352, s9
    s_cselect_b32 s17, 8192, s17
    s_cselect_b64 s[36:37], s[36:37], s[32:33]
    s_cselect_b32 s38, s38, s34
    s_add_u32 s16, s16, s73
    s_cmp_eq_u32 s24, 7
    s_cselect_b32 s34, 0, s34
    s_add_u32 s72, s24, s71
    s_and_b32 s73, s72, 1
    s_and_b32 s72, s72, 1
    v_and_b32 v11, 31, v0
    s_lshl_b32 s26, s69, 7
    s_add_u32 s26, s26, 159744
    v_lshlrev_b32 v11, 2, v11
    v_add_u32 v11, s26, v11
    ds_read_b32 v14, v11
    s_waitcnt lgkmcnt(0)
    v_rcp_f32 v13, v14
    v_mul_f32 v12, v14, v14
    v_mul_f32 v10, 0xc0135761, v13
    v_mul_f32 v11, v13, v13
    v_mul_f32 v11, 0x3d372713, v11
    v_mul_f32 v11, v10, v11
    v_mul_f32 v13, 0x3fb8aa3b, v13
    v_add_u32 v8, 24576, v7
    ds_read_b64_tr_b16 v[64:65], v8 offset:0
    ds_read_b64_tr_b16 v[66:67], v8 offset:512
    s_add_u32 m0, s75, 139264
    v_mfma_f32_32x32x16_bf16 v[112:127], v[72:75], v[144:147], 0
    s_setprio 1
    buffer_load_dwordx4 v4, s[44:47], s83 offen lds
    ds_read_b64_tr_b16 v[68:69], v8 offset:2048
    ds_read_b64_tr_b16 v[70:71], v8 offset:2560
    v_mfma_f32_32x32x16_bf16 v[112:127], v[76:79], v[148:151], v[112:127]
    ds_read_b64_tr_b16 v[72:73], v8 offset:4096
    ds_read_b64_tr_b16 v[74:75], v8 offset:4608
    v_mfma_f32_32x32x16_bf16 v[112:127], v[56:59], v[152:155], v[112:127]
    s_setprio 0
    ds_read_b64_tr_b16 v[76:77], v8 offset:6144
    ds_read_b64_tr_b16 v[78:79], v8 offset:6656
    s_waitcnt lgkmcnt(6)
    v_mfma_f32_32x32x16_bf16 v[112:127], v[60:63], v[156:159], v[112:127]
    s_waitcnt vmcnt(3)
    s_barrier
    v_mfma_f32_32x32x16_bf16 v[112:127], v[64:67], v[160:163], v[112:127]
    v_cvt_pk_bf16_f32 v32, v80, v81
    v_cvt_pk_bf16_f32 v33, v82, v83
    v_cvt_pk_bf16_f32 v34, v84, v85
    v_cvt_pk_bf16_f32 v35, v86, v87
    v_cvt_pk_bf16_f32 v36, v88, v89
    v_cvt_pk_bf16_f32 v37, v90, v91
    s_setprio 3
    v_add_u32 v8, 32768, v7
    ds_read_b64_tr_b16 v[56:57], v8 offset:0
    ds_read_b64_tr_b16 v[58:59], v8 offset:512
    buffer_atomic_add v53, v52, s[60:63], 0 offen sc1
    ds_read_b64_tr_b16 v[60:61], v8 offset:2048
    ds_read_b64_tr_b16 v[62:63], v8 offset:2560
    s_waitcnt lgkmcnt(6)
    s_add_u32 m0, s75, 0
    v_mfma_f32_32x32x16_bf16 v[112:127], v[68:71], v[164:167], v[112:127]
    v_cvt_pk_bf16_f32 v38, v92, v93
    v_cvt_pk_bf16_f32 v39, v94, v95
    v_mfma_f32_32x32x16_bf16 v[80:95], v[18:21], v[32:35], 0
    s_nop 0
    v_mfma_f32_32x32x16_bf16 v[80:95], v[22:25], v[36:39], v[80:95]
    buffer_load_dwordx4 v4, s[44:47], s84 offen lds
    ds_read_b64_tr_b16 v[64:65], v8 offset:4096
    ds_read_b64_tr_b16 v[66:67], v8 offset:4608
    v_mfma_f32_32x32x16_bf16 v[112:127], v[72:75], v[168:171], v[112:127]
    ds_read_b64_tr_b16 v[68:69], v8 offset:6144
    ds_read_b64_tr_b16 v[70:71], v8 offset:6656
    s_waitcnt lgkmcnt(6)
    s_add_u32 m0, s75, 8192
    v_mfma_f32_32x32x16_bf16 v[112:127], v[76:79], v[172:175], v[112:127]
    s_setprio 2
    buffer_load_dwordx4 v4, s[44:47], s85 offen lds
    v_add_u32 v8, 40960, v7
    ds_read_b64_tr_b16 v[72:73], v8 offset:0
    ds_read_b64_tr_b16 v[74:75], v8 offset:512
    v_mfma_f32_32x32x16_bf16 v[112:127], v[56:59], v[176:179], v[112:127]
    v_max3_f32 v26, v80, v81, v82
    v_max3_f32 v27, -v80, -v81, -v82
    v_max3_f32 v28, v83, v84, v85
    v_max3_f32 v29, -v83, -v84, -v85
    v_max3_f32 v26, v26, v86, v87
    v_max3_f32 v27, v27, -v86, -v87
    ds_read_b64_tr_b16 v[76:77], v8 offset:2048
    ds_read_b64_tr_b16 v[78:79], v8 offset:2560
    s_waitcnt lgkmcnt(6)
    s_add_u32 m0, s75, 147456
    v_mfma_f32_32x32x16_bf16 v[112:127], v[60:63], v[180:183], v[112:127]
    v_max3_f32 v28, v28, v88, v89
    v_max3_f32 v29, v29, -v88, -v89
    v_max3_f32 v26, v26, v90, v91
    v_max3_f32 v27, v27, -v90, -v91
    v_max3_f32 v28, v28, v92, v93
    v_max3_f32 v29, v29, -v92, -v93
    v_max_f32 v26, v26, v28
    buffer_load_dwordx4 v4, s[44:47], s86 offen lds
    ds_read_b64_tr_b16 v[56:57], v8 offset:4096
    ds_read_b64_tr_b16 v[58:59], v8 offset:4608
    v_mfma_f32_32x32x16_bf16 v[112:127], v[64:67], v[184:187], v[112:127]
    v_max_f32 v27, v27, v29
    s_nop 1
    v_permlane32_swap_b32 v26, v27
    v_max_f32 v26, v26, v27
    v_mul_f32 v26, v13, v26
    v_mov_b32 v27, v26
    s_setprio 1
    ds_read_b64_tr_b16 v[60:61], v8 offset:6144
    ds_read_b64_tr_b16 v[62:63], v8 offset:6656
    s_waitcnt lgkmcnt(6)
    v_mfma_f32_32x32x16_bf16 v[112:127], v[68:71], v[188:191], v[112:127]
    v_permlane32_swap_b32 v26, v27
    v_fma_f32 v96, v80, v13, -v26
    v_fma_f32 v80, -v80, v13, -v27
    v_fma_f32 v97, v81, v13, -v26
    v_fma_f32 v81, -v81, v13, -v27
    v_add_u32 v8, 114688, v7
    ds_read_b64_tr_b16 v[64:65], v8 offset:0
    ds_read_b64_tr_b16 v[66:67], v8 offset:512
    s_add_u32 m0, s75, 155648
    v_mfma_f32_32x32x16_bf16 v[112:127], v[72:75], v[192:195], v[112:127]
    v_exp_f32 v96, v96
    v_exp_f32 v80, v80
    v_exp_f32 v97, v97
    buffer_load_dwordx4 v4, s[44:47], s87 offen lds
    ds_read_b64_tr_b16 v[68:69], v8 offset:2048
    ds_read_b64_tr_b16 v[70:71], v8 offset:2560
    s_waitcnt lgkmcnt(6)
    v_mfma_f32_32x32x16_bf16 v[112:127], v[76:79], v[196:199], v[112:127]
    v_exp_f32 v81, v81
    v_fma_f32 v98, v82, v13, -v26
    v_fma_f32 v82, -v82, v13, -v27
    v_fma_f32 v99, v83, v13, -v26
    v_fma_f32 v83, -v83, v13, -v27
    v_exp_f32 v98, v98
    s_setprio 0
    ds_read_b64_tr_b16 v[72:73], v8 offset:4096
    ds_read_b64_tr_b16 v[74:75], v8 offset:4608
    v_mfma_f32_32x32x16_bf16 v[112:127], v[56:59], v[200:203], v[112:127]
    v_exp_f32 v82, v82
    v_exp_f32 v99, v99
    v_exp_f32 v83, v83
    ds_read_b64_tr_b16 v[76:77], v8 offset:6144
    ds_read_b64_tr_b16 v[78:79], v8 offset:6656
    s_waitcnt lgkmcnt(6)
    v_mfma_f32_32x32x16_bf16 v[112:127], v[60:63], v[204:207], v[112:127]
    s_waitcnt vmcnt(5)
    s_barrier
    v_mfma_f32_32x32x16_bf16 v[112:127], v[64:67], v[208:211], v[112:127]
    v_fma_f32 v100, v84, v13, -v26
    v_fma_f32 v84, -v84, v13, -v27
    v_fma_f32 v101, v85, v13, -v26
    v_fma_f32 v85, -v85, v13, -v27
    v_exp_f32 v100, v100
    s_setprio 3
    v_add_u32 v8, 122880, v7
    ds_read_b64_tr_b16 v[56:57], v8 offset:0
    ds_read_b64_tr_b16 v[58:59], v8 offset:512
    ds_read_b64_tr_b16 v[60:61], v8 offset:2048
    ds_read_b64_tr_b16 v[62:63], v8 offset:2560
    s_waitcnt lgkmcnt(6)
    s_add_u32 m0, s75, 16384
    v_mfma_f32_32x32x16_bf16 v[112:127], v[68:71], v[212:215], v[112:127]
    v_exp_f32 v84, v84
    v_exp_f32 v101, v101
    v_exp_f32 v85, v85
    v_fma_f32 v102, v86, v13, -v26
    buffer_load_dwordx4 v4, s[44:47], s88 offen lds
    ds_read_b64_tr_b16 v[64:65], v8 offset:4096
    ds_read_b64_tr_b16 v[66:67], v8 offset:4608
    v_mfma_f32_32x32x16_bf16 v[112:127], v[72:75], v[216:219], v[112:127]
    v_fma_f32 v86, -v86, v13, -v27
    v_fma_f32 v103, v87, v13, -v26
    v_fma_f32 v87, -v87, v13, -v27
    v_exp_f32 v102, v102
    v_exp_f32 v86, v86
    ds_read_b64_tr_b16 v[68:69], v8 offset:6144
    ds_read_b64_tr_b16 v[70:71], v8 offset:6656
    s_waitcnt lgkmcnt(6)
    s_add_u32 m0, s75, 24576
    v_mfma_f32_32x32x16_bf16 v[112:127], v[76:79], v[220:223], v[112:127]
    v_exp_f32 v103, v103
    v_exp_f32 v87, v87
    v_fma_f32 v104, v88, v13, -v26
    v_fma_f32 v88, -v88, v13, -v27
    s_setprio 2
    buffer_load_dwordx4 v4, s[44:47], s89 offen lds
    v_add_u32 v8, 131072, v7
    ds_read_b64_tr_b16 v[72:73], v8 offset:0
    ds_read_b64_tr_b16 v[74:75], v8 offset:512
    v_mfma_f32_32x32x16_bf16 v[112:127], v[56:59], v[224:227], v[112:127]
    v_fma_f32 v105, v89, v13, -v26
    v_fma_f32 v89, -v89, v13, -v27
    v_exp_f32 v104, v104
    v_exp_f32 v88, v88
    ds_read_b64_tr_b16 v[76:77], v8 offset:2048
    ds_read_b64_tr_b16 v[78:79], v8 offset:2560
    s_waitcnt lgkmcnt(6)
    s_add_u32 m0, s75, 32768
    v_mfma_f32_32x32x16_bf16 v[112:127], v[60:63], v[228:231], v[112:127]
    v_exp_f32 v105, v105
    v_exp_f32 v89, v89
    v_fma_f32 v106, v90, v13, -v26
    v_fma_f32 v90, -v90, v13, -v27
    v_fma_f32 v107, v91, v13, -v26
    buffer_load_dwordx4 v2, s[48:51], s76 offen lds
    ds_read_b64_tr_b16 v[56:57], v8 offset:4096
    ds_read_b64_tr_b16 v[58:59], v8 offset:4608
    v_mfma_f32_32x32x16_bf16 v[112:127], v[64:67], v[232:235], v[112:127]
    v_fma_f32 v91, -v91, v13, -v27
    v_exp_f32 v106, v106
    v_exp_f32 v90, v90
    v_exp_f32 v107, v107
    s_setprio 1
    ds_read_b64_tr_b16 v[60:61], v8 offset:6144
    ds_read_b64_tr_b16 v[62:63], v8 offset:6656
    s_waitcnt lgkmcnt(6)
    v_mfma_f32_32x32x16_bf16 v[112:127], v[68:71], v[236:239], v[112:127]
    v_exp_f32 v91, v91
    v_fma_f32 v108, v92, v13, -v26
    v_fma_f32 v92, -v92, v13, -v27
    v_fma_f32 v109, v93, v13, -v26
    v_fma_f32 v93, -v93, v13, -v27
    v_add_u32 v8, 139264, v7
    ds_read_b64_tr_b16 v[64:65], v8 offset:0
    ds_read_b64_tr_b16 v[66:67], v8 offset:512
    s_add_u32 m0, s75, 40960
    v_mfma_f32_32x32x16_bf16 v[112:127], v[72:75], v[240:243], v[112:127]
    v_exp_f32 v108, v108
    v_exp_f32 v92, v92
    v_exp_f32 v109, v109
    buffer_load_dwordx4 v2, s[48:51], s77 offen lds
    ds_read_b64_tr_b16 v[68:69], v8 offset:2048
    ds_read_b64_tr_b16 v[70:71], v8 offset:2560
    s_waitcnt lgkmcnt(6)
    v_mfma_f32_32x32x16_bf16 v[112:127], v[76:79], v[244:247], v[112:127]
    v_exp_f32 v93, v93
    v_add_f32 v26, v96, v97
    v_add_f32 v27, v80, v81
    v_add_f32 v28, v98, v99
    v_add_f32 v29, v82, v83
    v_add_f32 v26, v26, v100
    s_setprio 0
    ds_read_b64_tr_b16 v[72:73], v8 offset:4096
    ds_read_b64_tr_b16 v[74:75], v8 offset:4608
    v_mfma_f32_32x32x16_bf16 v[112:127], v[56:59], v[248:251], v[112:127]
    v_add_f32 v27, v27, v84
    v_add_f32 v28, v28, v101
    v_add_f32 v29, v29, v85
    v_add_f32 v26, v26, v102
    v_add_f32 v27, v27, v86
    v_add_f32 v28, v28, v103
    v_add_f32 v29, v29, v87
    ds_read_b64_tr_b16 v[76:77], v8 offset:6144
    ds_read_b64_tr_b16 v[78:79], v8 offset:6656
    s_waitcnt lgkmcnt(6)
    v_mfma_f32_32x32x16_bf16 v[112:127], v[60:63], v[252:255], v[112:127]
    s_waitcnt vmcnt(5)
    s_barrier
    v_mfma_f32_32x32x16_bf16 v[128:143], v[64:67], v[144:147], 0
    v_add_f32 v26, v26, v104
    v_add_f32 v27, v27, v88
    v_add_f32 v28, v28, v105
    v_add_f32 v29, v29, v89
    v_add_f32 v26, v26, v106
    v_add_f32 v27, v27, v90
    s_setprio 3
    v_add_u32 v8, 0, v7
    ds_read_b64_tr_b16 v[56:57], v8 offset:0
    ds_read_b64_tr_b16 v[58:59], v8 offset:512
    ds_read_b64_tr_b16 v[60:61], v8 offset:2048
    ds_read_b64_tr_b16 v[62:63], v8 offset:2560
    s_waitcnt lgkmcnt(6)
    s_add_u32 m0, s75, 114688
    v_mfma_f32_32x32x16_bf16 v[128:143], v[68:71], v[148:151], v[128:143]
    v_add_f32 v28, v28, v107
    v_add_f32 v29, v29, v91
    v_add_f32 v26, v26, v108
    v_add_f32 v27, v27, v92
    v_add_f32 v28, v28, v109
    v_add_f32 v29, v29, v93
    v_add_f32 v26, v26, v28
    buffer_load_dwordx4 v2, s[48:51], s78 offen lds
    ds_read_b64_tr_b16 v[64:65], v8 offset:4096
    ds_read_b64_tr_b16 v[66:67], v8 offset:4608
    v_mfma_f32_32x32x16_bf16 v[128:143], v[72:75], v[152:155], v[128:143]
    v_add_f32 v27, v27, v29
    s_nop 1
    v_permlane32_swap_b32 v26, v27
    v_add_f32 v26, v26, v27
    v_mul_f32 v26, v26, v14
    ds_read_b64_tr_b16 v[68:69], v8 offset:6144
    ds_read_b64_tr_b16 v[70:71], v8 offset:6656
    s_waitcnt lgkmcnt(6)
    v_mfma_f32_32x32x16_bf16 v[128:143], v[76:79], v[156:159], v[128:143]
    v_rcp_f32 v26, v26
    s_nop 0
    v_mov_b32 v27, v26
    s_nop 1
    v_permlane32_swap_b32 v26, v27
    v_mul_f32 v96, v96, v26
    v_mul_f32 v97, v97, v26
    v_mul_f32 v98, v98, v26
    s_setprio 2
    v_add_u32 v8, 8192, v7
    ds_read_b64_tr_b16 v[72:73], v8 offset:0
    ds_read_b64_tr_b16 v[74:75], v8 offset:512
    v_mfma_f32_32x32x16_bf16 v[128:143], v[56:59], v[160:163], v[128:143]
    v_mul_f32 v99, v99, v26
    v_cvt_pk_bf16_f32 v32, v96, v97
    v_cvt_pk_bf16_f32 v33, v98, v99
    ds_write_b64 v15, v[32:33] offset:0
    v_mul_f32 v100, v100, v26
    v_mul_f32 v101, v101, v26
    v_mul_f32 v102, v102, v26
    ds_read_b64_tr_b16 v[76:77], v8 offset:2048
    ds_read_b64_tr_b16 v[78:79], v8 offset:2560
    s_waitcnt lgkmcnt(7)
    s_add_u32 m0, s75, 122880
    v_mfma_f32_32x32x16_bf16 v[128:143], v[60:63], v[164:167], v[128:143]
    v_mul_f32 v103, v103, v26
    v_cvt_pk_bf16_f32 v34, v100, v101
    v_cvt_pk_bf16_f32 v35, v102, v103
    ds_write_b64 v15, v[34:35] offset:16
    v_mul_f32 v104, v104, v26
    v_mul_f32 v105, v105, v26
    v_mul_f32 v106, v106, v26
    buffer_load_dwordx4 v2, s[48:51], s79 offen lds
    ds_read_b64_tr_b16 v[56:57], v8 offset:4096
    ds_read_b64_tr_b16 v[58:59], v8 offset:4608
    v_mfma_f32_32x32x16_bf16 v[128:143], v[64:67], v[168:171], v[128:143]
    v_mul_f32 v107, v107, v26
    v_cvt_pk_bf16_f32 v36, v104, v105
    v_cvt_pk_bf16_f32 v37, v106, v107
    ds_write_b64 v15, v[36:37] offset:32
    v_mul_f32 v108, v108, v26
    v_mul_f32 v109, v109, v26
    v_cvt_pk_bf16_f32 v38, v108, v109
    s_setprio 1
    ds_read_b64_tr_b16 v[60:61], v8 offset:6144
    ds_read_b64_tr_b16 v[62:63], v8 offset:6656
    s_waitcnt lgkmcnt(9)
    v_mfma_f32_32x32x16_bf16 v[128:143], v[68:71], v[172:175], v[128:143]
    v_mov_b32 v39, 0
    ds_write_b64 v15, v[38:39] offset:48
    v_mul_f32 v80, v80, v27
    v_mul_f32 v81, v81, v27
    v_mul_f32 v82, v82, v27
    v_mul_f32 v83, v83, v27
    v_cvt_pk_bf16_f32 v40, v80, v81
    v_add_u32 v8, 147456, v7
    ds_read_b64_tr_b16 v[64:65], v8 offset:0
    ds_read_b64_tr_b16 v[66:67], v8 offset:512
    v_mfma_f32_32x32x16_bf16 v[128:143], v[72:75], v[176:179], v[128:143]
    v_cvt_pk_bf16_f32 v41, v82, v83
    ds_write_b64 v15, v[40:41] offset:64
    v_mul_f32 v84, v84, v27
    v_mul_f32 v85, v85, v27
    v_mul_f32 v86, v86, v27
    v_mul_f32 v87, v87, v27
    v_cvt_pk_bf16_f32 v42, v84, v85
    ds_read_b64_tr_b16 v[68:69], v8 offset:2048
    ds_read_b64_tr_b16 v[70:71], v8 offset:2560
    s_waitcnt lgkmcnt(9)
    v_mfma_f32_32x32x16_bf16 v[128:143], v[76:79], v[180:183], v[128:143]
    v_cvt_pk_bf16_f32 v43, v86, v87
    ds_write_b64 v15, v[42:43] offset:80
    v_mul_f32 v88, v88, v27
    v_mul_f32 v89, v89, v27
    v_mul_f32 v90, v90, v27
    v_mul_f32 v91, v91, v27
    v_cvt_pk_bf16_f32 v44, v88, v89
    s_setprio 0
    ds_read_b64_tr_b16 v[72:73], v8 offset:4096
    ds_read_b64_tr_b16 v[74:75], v8 offset:4608
    v_mfma_f32_32x32x16_bf16 v[128:143], v[56:59], v[184:187], v[128:143]
    v_cvt_pk_bf16_f32 v45, v90, v91
    ds_write_b64 v15, v[44:45] offset:96
    v_mul_f32 v92, v92, v27
    v_mul_f32 v93, v93, v27
    v_cvt_pk_bf16_f32 v46, v92, v93
    v_mov_b32 v47, 0
    ds_write_b64 v15, v[46:47] offset:112
    v_lshlrev_b32 v52, 6, v0
    buffer_load_dword v53, v52, s[60:63], 0 offen offset:0 sc1
    v_cmp_eq_u32 vcc, 2, v0
    s_nop 1
    v_cndmask_b32 v52, 0, 1, vcc
    v_cmp_gt_u32 vcc, 2, v0
    s_nop 1
    v_cndmask_b32 v52, v52, 64, vcc
    ds_read_b64_tr_b16 v[76:77], v8 offset:6144
    ds_read_b64_tr_b16 v[78:79], v8 offset:6656
    v_cvt_pk_bf16_f32 v40, v112, v113
    v_cvt_pk_bf16_f32 v41, v114, v115
    v_cvt_pk_bf16_f32 v42, v116, v117
    v_cvt_pk_bf16_f32 v43, v118, v119
    v_cvt_pk_bf16_f32 v44, v120, v121
    v_cvt_pk_bf16_f32 v45, v122, v123
    v_cvt_pk_bf16_f32 v46, v124, v125
    v_cvt_pk_bf16_f32 v47, v126, v127
    v_lshrrev_b32 v26, 16, v14
    v_cndmask_b32 v46, v46, v26, s[100:101]
    v_cndmask_b32 v47, v47, 0, s[100:101]
    ds_write_b64 v15, v[40:41] offset:128
    ds_write_b64 v15, v[42:43] offset:144
    ds_write_b64 v15, v[44:45] offset:160
    ds_write_b64 v15, v[46:47] offset:176
    s_waitcnt lgkmcnt(14)
    v_mfma_f32_32x32x16_bf16 v[128:143], v[60:63], v[188:191], v[128:143]
    s_waitcnt vmcnt(4) lgkmcnt(0)
    s_barrier
    v_mfma_f32_32x32x16_bf16 v[128:143], v[64:67], v[192:195], v[128:143]
    ds_read_b64_tr_b16 v[112:113], v17 offset:0
    ds_read_b64_tr_b16 v[114:115], v17 offset:232
    ds_read_b64_tr_b16 v[116:117], v16 offset:0
    ds_read_b64_tr_b16 v[118:119], v16 offset:232
    ds_read_b64_tr_b16 v[120:121], v16 offset:32
    ds_read_b64_tr_b16 v[122:123], v16 offset:264
    ds_read_b64_tr_b16 v[32:33], v17 offset:7424
    ds_read_b64_tr_b16 v[34:35], v17 offset:7656
    ds_read_b64_tr_b16 v[36:37], v16 offset:7424
    ds_read_b64_tr_b16 v[38:39], v16 offset:7656
    ds_read_b64_tr_b16 v[40:41], v16 offset:7456
    ds_read_b64_tr_b16 v[42:43], v16 offset:7688
    s_setprio 3
    v_add_u32 v8, 155648, v7
    ds_read_b64_tr_b16 v[56:57], v8 offset:0
    ds_read_b64_tr_b16 v[58:59], v8 offset:512
    ds_read_b64_tr_b16 v[60:61], v8 offset:2048
    ds_read_b64_tr_b16 v[62:63], v8 offset:2560
    s_add_u32 m0, s75, 131072
    v_mfma_f32_32x32x16_bf16 v[128:143], v[68:71], v[196:199], v[128:143]
    buffer_load_dwordx4 v2, s[48:51], s80 offen lds
    ds_read_b64_tr_b16 v[64:65], v8 offset:4096
    ds_read_b64_tr_b16 v[66:67], v8 offset:4608
    v_mfma_f32_32x32x16_bf16 v[128:143], v[72:75], v[200:203], v[128:143]
    s_waitcnt lgkmcnt(14)
    v_mfma_f32_16x16x32_bf16 v[124:127], v[116:119], v[112:115], 0
    s_waitcnt lgkmcnt(12)
    v_mfma_f32_16x16x32_bf16 v[44:47], v[120:123], v[112:115], 0
    ds_read_b64_tr_b16 v[112:113], v17 offset:14848
    ds_read_b64_tr_b16 v[114:115], v17 offset:15080
    ds_read_b64_tr_b16 v[116:117], v16 offset:14848
    ds_read_b64_tr_b16 v[118:119], v16 offset:15080
    ds_read_b64_tr_b16 v[120:121], v16 offset:14880
    ds_read_b64_tr_b16 v[68:69], v8 offset:6144
    ds_read_b64_tr_b16 v[70:71], v8 offset:6656
    s_waitcnt lgkmcnt(11)
    v_mfma_f32_32x32x16_bf16 v[128:143], v[76:79], v[204:207], v[128:143]
    ds_read_b64_tr_b16 v[122:123], v16 offset:15112
    v_add_u32 v8, 16384, v7
    ds_read_b64_tr_b16 v[72:73], v8 offset:0
    ds_read_b64_tr_b16 v[74:75], v8 offset:512
    v_mfma_f32_32x32x16_bf16 v[128:143], v[56:59], v[208:211], v[128:143]
    s_setprio 2
    ds_read_b64_tr_b16 v[76:77], v8 offset:2048
    ds_read_b64_tr_b16 v[78:79], v8 offset:2560
    s_waitcnt lgkmcnt(12)
    s_add_u32 m0, s75, 139264
    v_mfma_f32_32x32x16_bf16 v[128:143], v[60:63], v[212:215], v[128:143]
    v_mfma_f32_16x16x32_bf16 v[124:127], v[36:39], v[32:35], v[124:127]
    v_mfma_f32_16x16x32_bf16 v[44:47], v[40:43], v[32:35], v[44:47]
    ds_read_b64_tr_b16 v[32:33], v17 offset:22272
    ds_read_b64_tr_b16 v[34:35], v17 offset:22504
    ds_read_b64_tr_b16 v[36:37], v16 offset:22272
    ds_read_b64_tr_b16 v[38:39], v16 offset:22504
    ds_read_b64_tr_b16 v[40:41], v16 offset:22304
    buffer_load_dwordx4 v2, s[48:51], s81 offen lds
    ds_read_b64_tr_b16 v[56:57], v8 offset:4096
    ds_read_b64_tr_b16 v[58:59], v8 offset:4608
    v_mfma_f32_32x32x16_bf16 v[128:143], v[64:67], v[216:219], v[128:143]
    ds_read_b64_tr_b16 v[42:43], v16 offset:22536
    ds_read_b64_tr_b16 v[60:61], v8 offset:6144
    ds_read_b64_tr_b16 v[62:63], v8 offset:6656
    s_waitcnt lgkmcnt(12)
    v_mfma_f32_32x32x16_bf16 v[128:143], v[68:71], v[220:223], v[128:143]
    v_mfma_f32_16x16x32_bf16 v[124:127], v[116:119], v[112:115], v[124:127]
    v_mfma_f32_16x16x32_bf16 v[44:47], v[120:123], v[112:115], v[44:47]
    v_add_u32 v8, 24576, v7
    ds_read_b64_tr_b16 v[64:65], v8 offset:0
    ds_read_b64_tr_b16 v[66:67], v8 offset:512
    v_mfma_f32_32x32x16_bf16 v[128:143], v[72:75], v[224:227], v[128:143]
    s_setprio 1
    ds_read_b64_tr_b16 v[68:69], v8 offset:2048
    ds_read_b64_tr_b16 v[70:71], v8 offset:2560
    s_waitcnt lgkmcnt(7)
    s_add_u32 m0, s75, 0
    v_mfma_f32_32x32x16_bf16 v[128:143], v[76:79], v[228:231], v[128:143]
    v_mfma_f32_16x16x32_bf16 v[124:127], v[36:39], v[32:35], v[124:127]
    s_waitcnt lgkmcnt(6)
    v_mfma_f32_16x16x32_bf16 v[44:47], v[40:43], v[32:35], v[44:47]
    buffer_load_dwordx4 v2, s[48:51], s82 offen lds
    ds_read_b64_tr_b16 v[72:73], v8 offset:4096
    ds_read_b64_tr_b16 v[74:75], v8 offset:4608
    v_mfma_f32_32x32x16_bf16 v[128:143], v[56:59], v[232:235], v[128:143]
    ds_read_b64_tr_b16 v[76:77], v8 offset:6144
    ds_read_b64_tr_b16 v[78:79], v8 offset:6656
    s_waitcnt lgkmcnt(6)
    v_mfma_f32_32x32x16_bf16 v[128:143], v[60:63], v[236:239], v[128:143]
    buffer_store_dwordx4 v[124:127], v1, s[56:59], s91 offen offset:0 sc0 sc1
    buffer_store_dwordx4 v[44:47], v1, s[56:59], s91 offen offset:1024 sc0 sc1
    v_add_u32 v8, 32768, v6
    ds_read_b64_tr_b16 v[56:57], v8 offset:0
    ds_read_b64_tr_b16 v[58:59], v8 offset:256
    v_mfma_f32_32x32x16_bf16 v[128:143], v[64:67], v[240:243], v[128:143]
    s_setprio 0
    ds_read_b64_tr_b16 v[60:61], v8 offset:1024
    ds_read_b64_tr_b16 v[62:63], v8 offset:1280
    s_waitcnt lgkmcnt(6)
    v_mfma_f32_32x32x16_bf16 v[128:143], v[68:71], v[244:247], v[128:143]
    ds_read_b64_tr_b16 v[64:65], v8 offset:2048
    ds_read_b64_tr_b16 v[66:67], v8 offset:2304
    v_mfma_f32_32x32x16_bf16 v[128:143], v[72:75], v[248:251], v[128:143]
    ds_read_b64_tr_b16 v[68:69], v8 offset:3072
    ds_read_b64_tr_b16 v[70:71], v8 offset:3328
    s_waitcnt lgkmcnt(6)
    v_mfma_f32_32x32x16_bf16 v[128:143], v[76:79], v[252:255], v[128:143]
    s_waitcnt vmcnt(4)
    v_cmp_gt_u32 vcc, v52, v53
    s_cbranch_vccnz R_CFH
B_CFH:
    s_barrier
    v_mfma_f32_32x32x16_bf16 v[80:95], v[56:59], v[144:147], 0
    s_setprio 3
    v_add_u32 v8, 40960, v6
    ds_read_b64_tr_b16 v[72:73], v8 offset:0
    ds_read_b64_tr_b16 v[74:75], v8 offset:256
    s_lshl_b32 s3, s71, 10
    s_add_u32 s3, s3, 12648448
    v_mov_b32 v52, s3
    v_mov_b32 v53, 0x7ff00000
    v_cmp_eq_u32 vcc, 0, v0
    s_nop 1
    v_cndmask_b32 v52, v53, v52, vcc
    v_cndmask_b32 v5, 0, 1, vcc
    ds_read_b64_tr_b16 v[76:77], v8 offset:1024
    ds_read_b64_tr_b16 v[78:79], v8 offset:1280
    s_waitcnt lgkmcnt(6)
    v_mfma_f32_32x32x16_bf16 v[80:95], v[60:63], v[148:151], v[80:95]
    s_mul_i32 s25, s70, -131072
    s_add_u32 s25, s25, s23
    s_mul_i32 s83, s72, 688128
    s_add_u32 s83, s83, s6
    s_add_u32 m0, s25, 147456
    s_add_u32 s3, s83, 0
    buffer_load_dwordx4 v54, s[32:35], s3 offen lds
    ds_read_b64_tr_b16 v[56:57], v8 offset:2048
    ds_read_b64_tr_b16 v[58:59], v8 offset:2304
    v_mfma_f32_32x32x16_bf16 v[80:95], v[64:67], v[152:155], v[80:95]
    ds_read_b64_tr_b16 v[60:61], v8 offset:3072
    ds_read_b64_tr_b16 v[62:63], v8 offset:3328
    s_waitcnt lgkmcnt(6)
    v_mfma_f32_32x32x16_bf16 v[80:95], v[68:71], v[156:159], v[80:95]
    v_cvt_pk_bf16_f32 v32, v128, v129
    v_cvt_pk_bf16_f32 v33, v130, v131
    v_cvt_pk_bf16_f32 v34, v132, v133
    v_cvt_pk_bf16_f32 v35, v134, v135
    v_cvt_pk_bf16_f32 v36, v136, v137
    s_add_u32 m0, s25, 148480
    s_add_u32 s3, s83, 7168
    buffer_load_dwordx4 v54, s[32:35], s3 offen lds
    v_add_u32 v8, 114688, v6
    ds_read_b64_tr_b16 v[64:65], v8 offset:0
    ds_read_b64_tr_b16 v[66:67], v8 offset:256
    v_mfma_f32_32x32x16_bf16 v[80:95], v[72:75], v[160:163], v[80:95]
    v_cvt_pk_bf16_f32 v37, v138, v139
    v_cvt_pk_bf16_f32 v38, v140, v141
    v_cvt_pk_bf16_f32 v39, v142, v143
    v_mfma_f32_32x32x16_bf16 v[128:143], v[18:21], v[32:35], 0
    s_setprio 2
    ds_read_b64_tr_b16 v[68:69], v8 offset:1024
    ds_read_b64_tr_b16 v[70:71], v8 offset:1280
    s_waitcnt lgkmcnt(6)
    v_mfma_f32_32x32x16_bf16 v[80:95], v[76:79], v[164:167], v[80:95]
    v_mfma_f32_32x32x16_bf16 v[128:143], v[22:25], v[36:39], v[128:143]
    v_bfe_u32 v18, v0, 3, 3
    v_and_b32 v20, 7, v0
    v_lshlrev_b32 v18, 11, v18
    v_lshl_add_u32 v18, v20, 4, v18
    s_add_u32 m0, s25, 149504
    s_add_u32 s3, s83, 14336
    buffer_load_dwordx4 v54, s[32:35], s3 offen lds
    ds_read_b64_tr_b16 v[72:73], v8 offset:2048
    ds_read_b64_tr_b16 v[74:75], v8 offset:2304
    v_mfma_f32_32x32x16_bf16 v[80:95], v[56:59], v[168:171], v[80:95]
    v_add_u32 v19, 0x4000, v18
    v_and_b32 v22, 7, v0
    v_bfe_u32 v21, v0, 5, 1
    v_lshlrev_b32 v21, 2, v21
    v_lshl_add_u32 v21, v22, 4, v21
    v_and_b32 v23, 24, v0
    ds_read_b64_tr_b16 v[76:77], v8 offset:3072
    ds_read_b64_tr_b16 v[78:79], v8 offset:3328
    s_waitcnt lgkmcnt(6)
    v_mfma_f32_32x32x16_bf16 v[80:95], v[60:63], v[172:175], v[80:95]
    v_lshlrev_b32 v23, 26, v23
    v_or_b32 v21, v21, v23
    s_lshr_b32 s74, s69, 1
    s_and_b32 s74, s74, s71
    s_and_b32 s74, s74, 1
    s_cmp_eq_u32 s74, 1
    s_cselect_b32 s74, 5, 99
    v_max3_f32 v26, v128, v129, v130
    s_add_u32 m0, s25, 150528
    s_add_u32 s3, s83, 21504
    buffer_load_dwordx4 v54, s[32:35], s3 offen lds
    v_add_u32 v8, 122880, v6
    ds_read_b64_tr_b16 v[56:57], v8 offset:0
    ds_read_b64_tr_b16 v[58:59], v8 offset:256
    v_mfma_f32_32x32x16_bf16 v[80:95], v[64:67], v[176:179], v[80:95]
    v_max3_f32 v27, -v128, -v129, -v130
    v_max3_f32 v28, v131, v132, v133
    v_max3_f32 v29, -v131, -v132, -v133
    v_max3_f32 v26, v26, v134, v135
    v_max3_f32 v27, v27, -v134, -v135
    v_max3_f32 v28, v28, v136, v137
    s_setprio 1
    ds_read_b64_tr_b16 v[60:61], v8 offset:1024
    ds_read_b64_tr_b16 v[62:63], v8 offset:1280
    s_waitcnt lgkmcnt(6)
    v_mfma_f32_32x32x16_bf16 v[80:95], v[68:71], v[180:183], v[80:95]
    v_max3_f32 v29, v29, -v136, -v137
    v_max3_f32 v26, v26, v138, v139
    v_max3_f32 v27, v27, -v138, -v139
    v_max3_f32 v28, v28, v140, v141
    v_max3_f32 v29, v29, -v140, -v141
    s_mul_i32 s25, s70, 16384
    s_add_u32 s25, s25, s23
    s_mul_i32 s83, s72, -688128
    s_add_u32 s83, s83, s6
    s_add_u32 m0, s25, 49152
    s_add_u32 s3, s83, 688128
    buffer_load_dwordx4 v54, s[32:35], s3 offen lds
    ds_read_b64_tr_b16 v[64:65], v8 offset:2048
    ds_read_b64_tr_b16 v[66:67], v8 offset:2304
    v_mfma_f32_32x32x16_bf16 v[80:95], v[72:75], v[184:187], v[80:95]
    v_max_f32 v26, v26, v28
    v_max_f32 v27, v27, v29
    s_nop 1
    v_permlane32_swap_b32 v26, v27
    v_max_f32 v26, v26, v27
    v_mul_f32 v26, v13, v26
    ds_read_b64_tr_b16 v[68:69], v8 offset:3072
    ds_read_b64_tr_b16 v[70:71], v8 offset:3328
    s_waitcnt lgkmcnt(6)
    v_mfma_f32_32x32x16_bf16 v[80:95], v[76:79], v[188:191], v[80:95]
    v_mov_b32 v27, v26
    s_nop 1
    v_permlane32_swap_b32 v26, v27
    v_fma_f32 v112, v128, v13, -v26
    v_fma_f32 v128, -v128, v13, -v27
    s_add_u32 m0, s25, 50176
    s_add_u32 s3, s83, 695296
    buffer_load_dwordx4 v54, s[32:35], s3 offen lds
    v_add_u32 v8, 131072, v6
    ds_read_b64_tr_b16 v[72:73], v8 offset:0
    ds_read_b64_tr_b16 v[74:75], v8 offset:256
    v_mfma_f32_32x32x16_bf16 v[80:95], v[56:59], v[192:195], v[80:95]
    v_fma_f32 v113, v129, v13, -v26
    v_fma_f32 v129, -v129, v13, -v27
    v_exp_f32 v112, v112
    v_exp_f32 v128, v128
    s_setprio 0
    ds_read_b64_tr_b16 v[76:77], v8 offset:1024
    ds_read_b64_tr_b16 v[78:79], v8 offset:1280
    s_waitcnt lgkmcnt(6)
    v_mfma_f32_32x32x16_bf16 v[80:95], v[60:63], v[196:199], v[80:95]
    v_exp_f32 v113, v113
    v_exp_f32 v129, v129
    v_fma_f32 v114, v130, v13, -v26
    s_add_u32 m0, s25, 51200
    s_add_u32 s3, s83, 702464
    buffer_load_dwordx4 v54, s[32:35], s3 offen lds
    ds_read_b64_tr_b16 v[56:57], v8 offset:2048
    ds_read_b64_tr_b16 v[58:59], v8 offset:2304
    v_mfma_f32_32x32x16_bf16 v[80:95], v[64:67], v[200:203], v[80:95]
    v_fma_f32 v130, -v130, v13, -v27
    v_fma_f32 v115, v131, v13, -v26
    buffer_load_dwordx4 v[22:25], v18, s[56:59], s92 offen sc1
    buffer_load_dwordx4 v[48:51], v19, s[56:59], s92 offen sc1
    v_fma_f32 v131, -v131, v13, -v27
    v_exp_f32 v114, v114
    ds_read_b64_tr_b16 v[60:61], v8 offset:3072
    ds_read_b64_tr_b16 v[62:63], v8 offset:3328
    s_waitcnt lgkmcnt(6)
    v_mfma_f32_32x32x16_bf16 v[80:95], v[68:71], v[204:207], v[80:95]
    s_waitcnt vmcnt(11)
    s_barrier
    v_mfma_f32_32x32x16_bf16 v[80:95], v[72:75], v[208:211], v[80:95]
    v_exp_f32 v130, v130
    v_exp_f32 v115, v115
    s_setprio 3
    v_add_u32 v8, 139264, v6
    ds_read_b64_tr_b16 v[64:65], v8 offset:0
    ds_read_b64_tr_b16 v[66:67], v8 offset:256
    ds_read_b64_tr_b16 v[68:69], v8 offset:1024
    ds_read_b64_tr_b16 v[70:71], v8 offset:1280
    s_waitcnt lgkmcnt(6)
    v_mfma_f32_32x32x16_bf16 v[80:95], v[76:79], v[212:215], v[80:95]
    v_exp_f32 v131, v131
    v_fma_f32 v116, v132, v13, -v26
    v_fma_f32 v132, -v132, v13, -v27
    v_fma_f32 v117, v133, v13, -v26
    v_fma_f32 v133, -v133, v13, -v27
    s_add_u32 m0, s25, 52224
    s_add_u32 s3, s83, 709632
    buffer_load_dwordx4 v54, s[32:35], s3 offen lds
    ds_read_b64_tr_b16 v[72:73], v8 offset:2048
    ds_read_b64_tr_b16 v[74:75], v8 offset:2304
    v_mfma_f32_32x32x16_bf16 v[80:95], v[56:59], v[216:219], v[80:95]
    v_exp_f32 v116, v116
    v_exp_f32 v132, v132
    v_exp_f32 v117, v117
    ds_read_b64_tr_b16 v[76:77], v8 offset:3072
    ds_read_b64_tr_b16 v[78:79], v8 offset:3328
    s_waitcnt lgkmcnt(6)
    v_mfma_f32_32x32x16_bf16 v[80:95], v[60:63], v[220:223], v[80:95]
    v_exp_f32 v133, v133
    v_fma_f32 v118, v134, v13, -v26
    v_fma_f32 v134, -v134, v13, -v27
    v_fma_f32 v119, v135, v13, -v26
    v_fma_f32 v135, -v135, v13, -v27
    s_setprio 2
    s_mul_i32 s25, s70, 16384
    s_add_u32 s25, s25, s23
    s_mul_i32 s83, s72, 688128
    s_add_u32 s83, s83, s6
    s_add_u32 m0, s25, 81920
    s_add_u32 s3, s83, 57344
    buffer_load_dwordx4 v54, s[32:35], s3 offen lds
    buffer_load_dword v53, v52, s[56:59], 0 offen offset:0 sc1
    v_add_u32 v8, 0, v6
    ds_read_b64_tr_b16 v[56:57], v8 offset:0
    ds_read_b64_tr_b16 v[58:59], v8 offset:256
    v_mfma_f32_32x32x16_bf16 v[80:95], v[64:67], v[224:227], v[80:95]
    v_exp_f32 v118, v118
    v_exp_f32 v134, v134
    ds_read_b64_tr_b16 v[60:61], v8 offset:1024
    ds_read_b64_tr_b16 v[62:63], v8 offset:1280
    s_waitcnt lgkmcnt(6)
    v_mfma_f32_32x32x16_bf16 v[80:95], v[68:71], v[228:231], v[80:95]
    v_exp_f32 v119, v119
    v_exp_f32 v135, v135
    v_fma_f32 v120, v136, v13, -v26
    v_fma_f32 v136, -v136, v13, -v27
    v_fma_f32 v121, v137, v13, -v26
    s_add_u32 m0, s25, 82944
    s_add_u32 s3, s83, 64512
    buffer_load_dwordx4 v54, s[32:35], s3 offen lds
    ds_read_b64_tr_b16 v[64:65], v8 offset:2048
    ds_read_b64_tr_b16 v[66:67], v8 offset:2304
    v_mfma_f32_32x32x16_bf16 v[80:95], v[72:75], v[232:235], v[80:95]
    v_fma_f32 v137, -v137, v13, -v27
    v_exp_f32 v120, v120
    v_exp_f32 v136, v136
    s_setprio 1
    ds_read_b64_tr_b16 v[68:69], v8 offset:3072
    ds_read_b64_tr_b16 v[70:71], v8 offset:3328
    s_waitcnt lgkmcnt(6)
    v_mfma_f32_32x32x16_bf16 v[80:95], v[76:79], v[236:239], v[80:95]
    v_exp_f32 v121, v121
    v_exp_f32 v137, v137
    v_fma_f32 v122, v138, v13, -v26
    v_fma_f32 v138, -v138, v13, -v27
    s_add_u32 m0, s25, 83968
    s_add_u32 s3, s83, 71680
    buffer_load_dwordx4 v54, s[32:35], s3 offen lds
    v_mfma_f32_32x32x16_bf16 v[80:95], v[56:59], v[240:243], v[80:95]
    v_fma_f32 v123, v139, v13, -v26
    v_fma_f32 v139, -v139, v13, -v27
    v_exp_f32 v122, v122
    s_waitcnt lgkmcnt(2)
    v_mfma_f32_32x32x16_bf16 v[80:95], v[60:63], v[244:247], v[80:95]
    v_exp_f32 v138, v138
    v_exp_f32 v123, v123
    v_exp_f32 v139, v139
    v_fma_f32 v124, v140, v13, -v26
    s_setprio 0
    s_add_u32 m0, s25, 84992
    s_add_u32 s3, s83, 78848
    buffer_load_dwordx4 v54, s[32:35], s3 offen lds
    v_mfma_f32_32x32x16_bf16 v[80:95], v[64:67], v[248:251], v[80:95]
    v_fma_f32 v140, -v140, v13, -v27
    v_fma_f32 v125, v141, v13, -v26
    v_fma_f32 v141, -v141, v13, -v27
    v_exp_f32 v124, v124
    s_waitcnt lgkmcnt(0)
    v_mfma_f32_32x32x16_bf16 v[80:95], v[68:71], v[252:255], v[80:95]
    v_exp_f32 v140, v140
    v_exp_f32 v125, v125
    v_exp_f32 v141, v141
    s_mul_i32 s25, s70, 81920
    s_add_u32 s25, s25, s23
    s_mul_i32 s83, s72, -688128
    s_add_u32 s83, s83, s6
    s_add_u32 m0, s25, 32768
    s_add_u32 s3, s83, 745472
    buffer_load_dwordx4 v54, s[32:35], s3 offen lds
    s_setprio 0
    s_waitcnt vmcnt(8)
    v_max3_u32 v30, v22, v23, v24
    s_waitcnt vmcnt(7)
    v_max3_u32 v30, v30, v25, v48
    v_max3_u32 v30, v30, v49, v50
    v_max_u32 v30, v30, v51
    v_cmp_eq_u32 vcc, -1, v30
    s_cbranch_vccnz R_KP
B_KP:
    v_add_f32 v22, v22, v48
    v_add_f32 v23, v23, v49
    v_add_f32 v24, v24, v50
    v_add_f32 v25, v25, v51
    v_add_f32_dpp v22, v22, v22 row_ror:8 row_mask:0xf bank_mask:0xf
    v_add_f32_dpp v23, v23, v23 row_ror:8 row_mask:0xf bank_mask:0xf
    v_add_f32_dpp v24, v24, v24 row_ror:8 row_mask:0xf bank_mask:0xf
    v_add_f32_dpp v25, v25, v25 row_ror:8 row_mask:0xf bank_mask:0xf
    v_permlane16_swap_b32 v22, v23
    s_nop 0
    v_permlane16_swap_b32 v24, v25
    v_add_f32 v22, v22, v23
    v_add_f32 v24, v24, v25
    s_nop 1
    v_permlane32_swap_b32 v22, v24
    v_add_f32 v22, v22, v24
    v_cmp_eq_u32 vcc, s74, v20
    s_nop 1
    v_cndmask_b32 v22, v22, 1.0, vcc
    v_mov_b32 v23, v22
    s_nop 1
    v_permlane16_swap_b32 v22, v23
    v_cvt_pk_bf16_f32 v22, v22, v23
    buffer_store_dword v22, v21, s[56:59], s93 offen sc0 sc1
    s_waitcnt vmcnt(5)
    v_lshrrev_b32 v53, 3, v53
    v_cmp_gt_u32 vcc, v5, v53
    s_cbranch_vccnz R_P0H
B_P0H:
    s_barrier
    s_cmp_eq_u32 s24, 7
    s_cbranch_scc1 KM_NOTILE
    v_pk_mul_f32 v[60:61], v[80:81], v[80:81]
    v_pk_mul_f32 v[62:63], v[82:83], v[82:83]
    v_pk_fma_f32 v[60:61], v[60:61], v[10:11], v[10:11] op_sel:[0,1,0] op_sel_hi:[1,1,0]
    s_mul_i32 s84, s72, 49152
    s_add_u32 s84, s84, s14
    buffer_load_dwordx4 v[144:147], v1, s[56:59], s84 offen offset:0 sc1
    v_pk_fma_f32 v[62:63], v[62:63], v[10:11], v[10:11] op_sel:[0,1,0] op_sel_hi:[1,1,0]
    v_pk_mul_f32 v[60:61], v[80:81], v[60:61]
    v_pk_mul_f32 v[62:63], v[82:83], v[62:63]
    v_exp_f32 v60, v60
    v_exp_f32 v61, v61
    v_pk_mul_f32 v[88:89], v[80:81], v[88:89]
    v_exp_f32 v62, v62
    buffer_load_dwordx4 v[148:151], v1, s[56:59], s84 offen offset:1024 sc1
    v_exp_f32 v63, v63
    v_pk_mul_f32 v[90:91], v[82:83], v[90:91]
    v_pk_fma_f32 v[60:61], v[60:61], v[12:13], v[12:13] op_sel_hi:[1,0,0]
    v_pk_fma_f32 v[62:63], v[62:63], v[12:13], v[12:13] op_sel_hi:[1,0,0]
    v_rcp_f32 v60, v60
    v_rcp_f32 v61, v61
    v_rcp_f32 v62, v62
    v_rcp_f32 v63, v63
    buffer_load_dwordx4 v[152:155], v1, s[56:59], s84 offen offset:2048 sc1
    v_pk_mul_f32 v[88:89], v[88:89], v[60:61]
    v_pk_mul_f32 v[90:91], v[90:91], v[62:63]
    v_cvt_pk_bf16_f32 v56, v88, v89
    v_cvt_pk_bf16_f32 v57, v90, v91
    v_pk_mul_f32 v[60:61], v[84:85], v[84:85]
    v_pk_mul_f32 v[62:63], v[86:87], v[86:87]
    v_pk_fma_f32 v[60:61], v[60:61], v[10:11], v[10:11] op_sel:[0,1,0] op_sel_hi:[1,1,0]
    v_pk_fma_f32 v[62:63], v[62:63], v[10:11], v[10:11] op_sel:[0,1,0] op_sel_hi:[1,1,0]
    buffer_load_dwordx4 v[156:159], v1, s[56:59], s84 offen offset:3072 sc1
    v_pk_mul_f32 v[60:61], v[84:85], v[60:61]
    v_pk_mul_f32 v[62:63], v[86:87], v[62:63]
    v_exp_f32 v60, v60
    v_exp_f32 v61, v61
    v_pk_mul_f32 v[92:93], v[84:85], v[92:93]
    v_exp_f32 v62, v62
    v_exp_f32 v63, v63
    s_mul_i32 s84, s72, -49152
    s_add_u32 s84, s84, s14
    s_add_u32 s84, s84, 49152
    buffer_load_dwordx4 v[160:163], v1, s[56:59], s84 offen offset:0 sc1
    v_pk_mul_f32 v[94:95], v[86:87], v[94:95]
    v_pk_fma_f32 v[60:61], v[60:61], v[12:13], v[12:13] op_sel_hi:[1,0,0]
    v_pk_fma_f32 v[62:63], v[62:63], v[12:13], v[12:13] op_sel_hi:[1,0,0]
    v_rcp_f32 v60, v60
    v_rcp_f32 v61, v61
    v_rcp_f32 v62, v62
    v_rcp_f32 v63, v63
    v_pk_mul_f32 v[92:93], v[92:93], v[60:61]
    buffer_load_dwordx4 v[164:167], v1, s[56:59], s84 offen offset:1024 sc1
    v_pk_mul_f32 v[94:95], v[94:95], v[62:63]
    v_cvt_pk_bf16_f32 v58, v92, v93
    v_cvt_pk_bf16_f32 v59, v94, v95
    buffer_store_dwordx4 v[56:59], v1, s[56:59], s99 offen sc0 sc1
    v_cvt_pk_bf16_f32 v32, v112, v113
    v_cvt_pk_bf16_f32 v33, v114, v115
    v_cvt_pk_bf16_f32 v34, v116, v117
    v_cvt_pk_bf16_f32 v35, v118, v119
    buffer_load_dwordx4 v[168:171], v1, s[56:59], s84 offen offset:2048 sc1
    v_cvt_pk_bf16_f32 v36, v120, v121
    v_cvt_pk_bf16_f32 v37, v122, v123
    v_cvt_pk_bf16_f32 v38, v124, v125
    v_mov_b32 v39, 0
    v_cvt_pk_bf16_f32 v40, v128, v129
    v_cvt_pk_bf16_f32 v41, v130, v131
    v_cvt_pk_bf16_f32 v42, v132, v133
    buffer_load_dwordx4 v[172:175], v1, s[56:59], s84 offen offset:3072 sc1
    v_cvt_pk_bf16_f32 v43, v134, v135
    v_cvt_pk_bf16_f32 v44, v136, v137
    v_cvt_pk_bf16_f32 v45, v138, v139
    v_cvt_pk_bf16_f32 v46, v140, v141
    v_mov_b32 v47, 0
    v_bfe_u32 v26, v0, 5, 1
    v_bfe_u32 v27, v0, 2, 2
    v_lshl_add_u32 v27, v26, 2, v27
    v_and_b32 v28, 3, v0
    v_lshlrev_b32 v28, 3, v28
    v_bfe_u32 v29, v0, 4, 1
    v_lshl_add_u32 v28, v29, 5, v28
    v_bfe_u32 v29, v0, 3, 1
    v_lshl_add_u32 v28, v29, 6, v28
    v_lshl_add_u32 v27, v27, 7, v28
    s_and_b32 s26, s22, 1
    s_lshl_b32 s26, s26, 13
    v_add_u32 v7, s26, v27
    v_and_b32 v27, 7, v0
    v_xor_b32 v28, v26, v27
    v_and_b32 v29, 31, v0
    v_bfe_u32 v26, v0, 6, 1
    v_lshl_add_u32 v29, v26, 5, v29
    v_lshlrev_b32 v29, 8, v29
    v_lshl_add_u32 v20, v28, 4, v29
    v_lshrrev_b32 v26, 3, v0
    v_and_b32 v28, 7, v26
    v_lshlrev_b32 v29, 1, v27
    v_xor_b32 v29, v29, v28
    v_lshlrev_b32 v29, 4, v29
    v_lshl_add_u32 v19, v26, 8, v29
    v_mul_u32_u24 v21, 896, v26
    v_lshl_add_u32 v21, v27, 4, v21
    s_and_b32 s26, s68, 5
    s_cmp_eq_u32 s26, 1
    s_cselect_b32 s26, 3584, 0
    v_subrev_u32 v4, s26, v54
    s_barrier
    s_mul_i32 s26, s70, -131072
    s_add_u32 s26, s26, 147456
    v_add_u32 v8, s26, v7
    v_xor_b32 v9, 64, v8
    ds_read_b64_tr_b16 v[56:57], v8 offset:0
    ds_read_b64_tr_b16 v[58:59], v8 offset:1024
    ds_read_b64_tr_b16 v[60:61], v9 offset:0
    ds_read_b64_tr_b16 v[62:63], v9 offset:1024
    ds_read_b64_tr_b16 v[64:65], v8 offset:2048
    ds_read_b64_tr_b16 v[66:67], v8 offset:3072
    ds_read_b64_tr_b16 v[68:69], v9 offset:2048
    ds_read_b64_tr_b16 v[70:71], v9 offset:3072
    ds_read_b64_tr_b16 v[72:73], v8 offset:4096
    ds_read_b64_tr_b16 v[74:75], v8 offset:5120
    s_waitcnt vmcnt(8) lgkmcnt(8)
    v_mfma_f32_32x32x16_bf16 v[112:127], v[56:59], v[144:147], 0
    s_add_u32 m0, s25, 33792
    s_add_u32 s3, s83, 752640
    buffer_load_dwordx4 v54, s[32:35], s3 offen lds
    ds_read_b64_tr_b16 v[76:77], v9 offset:4096
    ds_read_b64_tr_b16 v[78:79], v9 offset:5120
    s_waitcnt lgkmcnt(8)
    v_mfma_f32_32x32x16_bf16 v[128:143], v[60:63], v[144:147], 0
    s_add_u32 m0, s25, 34816
    s_add_u32 s3, s83, 759808
    buffer_load_dwordx4 v54, s[32:35], s3 offen lds
    ds_read_b64_tr_b16 v[56:57], v8 offset:6144
    ds_read_b64_tr_b16 v[58:59], v8 offset:7168
    s_waitcnt vmcnt(9) lgkmcnt(8)
    v_mfma_f32_32x32x16_bf16 v[112:127], v[64:67], v[148:151], v[112:127]
    s_add_u32 m0, s25, 35840
    s_add_u32 s3, s83, 766976
    buffer_load_dwordx4 v54, s[32:35], s3 offen lds
    ds_read_b64_tr_b16 v[60:61], v9 offset:6144
    ds_read_b64_tr_b16 v[62:63], v9 offset:7168
    s_waitcnt lgkmcnt(8)
    v_mfma_f32_32x32x16_bf16 v[128:143], v[68:71], v[148:151], v[128:143]
    buffer_load_dwordx4 v[240:243], v1, s[56:59], s96 offen offset:0 sc1
    s_mul_i32 s26, s70, 16384
    s_add_u32 s26, s26, 49152
    v_add_u32 v8, s26, v7
    v_xor_b32 v9, 64, v8
    ds_read_b64_tr_b16 v[64:65], v8 offset:0
    ds_read_b64_tr_b16 v[66:67], v8 offset:1024
    s_waitcnt vmcnt(10) lgkmcnt(8)
    v_mfma_f32_32x32x16_bf16 v[112:127], v[72:75], v[152:155], v[112:127]
    buffer_load_dwordx4 v[244:247], v1, s[56:59], s96 offen offset:1024 sc1
    ds_read_b64_tr_b16 v[68:69], v9 offset:0
    ds_read_b64_tr_b16 v[70:71], v9 offset:1024
    s_waitcnt lgkmcnt(8)
    v_mfma_f32_32x32x16_bf16 v[128:143], v[76:79], v[152:155], v[128:143]
    buffer_load_dwordx4 v[248:251], v1, s[56:59], s96 offen offset:2048 sc1
    ds_read_b64_tr_b16 v[72:73], v8 offset:2048
    ds_read_b64_tr_b16 v[74:75], v8 offset:3072
    s_waitcnt vmcnt(11) lgkmcnt(8)
    v_mfma_f32_32x32x16_bf16 v[112:127], v[56:59], v[156:159], v[112:127]
    buffer_load_dwordx4 v[252:255], v1, s[56:59], s96 offen offset:3072 sc1
    ds_read_b64_tr_b16 v[76:77], v9 offset:2048
    ds_read_b64_tr_b16 v[78:79], v9 offset:3072
    s_waitcnt lgkmcnt(8)
    v_mfma_f32_32x32x16_bf16 v[128:143], v[60:63], v[156:159], v[128:143]
    s_waitcnt vmcnt(9)
    s_barrier
    buffer_atomic_add v5, v52, s[56:59], 0 offen offset:512 sc1
    ds_read_b64_tr_b16 v[56:57], v8 offset:4096
    ds_read_b64_tr_b16 v[58:59], v8 offset:5120
    s_waitcnt lgkmcnt(8)
    v_mfma_f32_32x32x16_bf16 v[112:127], v[64:67], v[160:163], v[112:127]
    s_mul_i32 s25, s70, -131072
    s_add_u32 s25, s25, s23
    s_mov_b32 s83, s7
    s_add_u32 m0, s25, 131072
    s_add_u32 s3, s83, 0
    buffer_load_dwordx4 v54, s[32:35], s3 offen lds
    ds_read_b64_tr_b16 v[60:61], v9 offset:4096
    ds_read_b64_tr_b16 v[62:63], v9 offset:5120
    s_waitcnt lgkmcnt(8)
    v_mfma_f32_32x32x16_bf16 v[128:143], v[68:71], v[160:163], v[128:143]
    s_add_u32 m0, s25, 132096
    s_add_u32 s3, s83, 7168
    buffer_load_dwordx4 v54, s[32:35], s3 offen lds
    ds_read_b64_tr_b16 v[64:65], v8 offset:6144
    ds_read_b64_tr_b16 v[66:67], v8 offset:7168
    s_waitcnt lgkmcnt(8)
    v_mfma_f32_32x32x16_bf16 v[112:127], v[72:75], v[164:167], v[112:127]
    ds_read_b64_tr_b16 v[68:69], v9 offset:6144
    ds_read_b64_tr_b16 v[70:71], v9 offset:7168
    s_waitcnt lgkmcnt(8)
    v_mfma_f32_32x32x16_bf16 v[128:143], v[76:79], v[164:167], v[128:143]
    s_add_u32 m0, s25, 133120
    s_add_u32 s3, s83, 14336
    buffer_load_dwordx4 v54, s[32:35], s3 offen lds
    s_waitcnt vmcnt(12) lgkmcnt(6)
    v_mfma_f32_32x32x16_bf16 v[112:127], v[56:59], v[168:171], v[112:127]
    s_waitcnt lgkmcnt(4)
    v_mfma_f32_32x32x16_bf16 v[128:143], v[60:63], v[168:171], v[128:143]
    s_add_u32 m0, s25, 134144
    s_add_u32 s3, s83, 21504
    buffer_load_dwordx4 v54, s[32:35], s3 offen lds
    s_waitcnt vmcnt(12) lgkmcnt(2)
    v_mfma_f32_32x32x16_bf16 v[112:127], v[64:67], v[172:175], v[112:127]
    s_waitcnt lgkmcnt(0)
    v_mfma_f32_32x32x16_bf16 v[128:143], v[68:71], v[172:175], v[128:143]
    s_waitcnt vmcnt(8)
    v_max3_u32 v26, v240, v241, v242
    s_waitcnt vmcnt(7)
    v_max3_u32 v27, v243, v244, v245
    v_max3_u32 v26, v26, v246, v247
    s_waitcnt vmcnt(6)
    v_max3_u32 v27, v27, v248, v249
    v_max3_u32 v26, v26, v250, v251
    s_waitcnt vmcnt(5)
    v_max3_u32 v27, v27, v252, v253
    v_max3_u32 v26, v26, v254, v255
    v_max_u32 v26, v26, v27
    v_cmp_eq_u32 vcc, -1, v26
    s_cbranch_vccnz R_KF
B_KF:
    v_mfma_f32_32x32x16_bf16 v[80:95], v[240:243], v[32:35], 0
    v_mfma_f32_32x32x16_bf16 v[96:111], v[248:251], v[40:43], 0
    v_mfma_f32_32x32x16_bf16 v[80:95], v[244:247], v[36:39], v[80:95]
    v_mfma_f32_32x32x16_bf16 v[96:111], v[252:255], v[44:47], v[96:111]
    s_mul_i32 s25, s70, -131072
    s_add_u32 s25, s25, s23
    s_xor_b32 s83, s73, 0
    s_mul_i32 s83, s83, s9
    s_add_u32 s83, s83, s8
    s_add_u32 m0, s25, 147456
    s_add_u32 s3, s83, 0
    buffer_load_dwordx4 v4, s[36:39], s3 offen lds
    s_nop 2
    v_rcp_f32 v26, v93
    v_rcp_f32 v27, v109
    v_mov_b32 v28, 0x358637bd
    v_fmac_f32 v28, v26, v92
    v_fmac_f32 v28, v27, v108
    v_rcp_f32 v28, v28
    s_nop 0
    v_mul_f32 v26, v26, v28
    v_mul_f32 v27, v27, v28
    v_mov_b32 v29, v26
    v_mov_b32 v30, v27
    s_nop 0
    v_permlane32_swap_b32 v29, v26
    s_add_u32 m0, s25, 148480
    s_add_u32 s3, s83, 7168
    buffer_load_dwordx4 v4, s[36:39], s3 offen lds
    v_permlane32_swap_b32 v30, v27
    v_pk_mul_f32 v[80:81], v[80:81], v[26:27] op_sel_hi:[1,0]
    v_pk_mul_f32 v[82:83], v[82:83], v[26:27] op_sel_hi:[1,0]
    v_pk_mul_f32 v[84:85], v[84:85], v[26:27] op_sel_hi:[1,0]
    v_pk_mul_f32 v[86:87], v[86:87], v[26:27] op_sel_hi:[1,0]
    v_pk_mul_f32 v[88:89], v[88:89], v[26:27] op_sel_hi:[1,0]
    v_pk_mul_f32 v[90:91], v[90:91], v[26:27] op_sel_hi:[1,0]
    v_pk_mul_f32 v[92:93], v[92:93], v[26:27] op_sel_hi:[1,0]
    v_pk_mul_f32 v[94:95], v[94:95], v[26:27] op_sel_hi:[1,0]
    v_pk_fma_f32 v[80:81], v[96:97], v[26:27], v[80:81] op_sel:[0,1,0] op_sel_hi:[1,1,1]
    v_pk_fma_f32 v[82:83], v[98:99], v[26:27], v[82:83] op_sel:[0,1,0] op_sel_hi:[1,1,1]
    s_add_u32 m0, s25, 149504
    s_add_u32 s3, s83, 14336
    buffer_load_dwordx4 v4, s[36:39], s3 offen lds
    v_pk_fma_f32 v[84:85], v[100:101], v[26:27], v[84:85] op_sel:[0,1,0] op_sel_hi:[1,1,1]
    v_pk_fma_f32 v[86:87], v[102:103], v[26:27], v[86:87] op_sel:[0,1,0] op_sel_hi:[1,1,1]
    v_pk_fma_f32 v[88:89], v[104:105], v[26:27], v[88:89] op_sel:[0,1,0] op_sel_hi:[1,1,1]
    v_pk_fma_f32 v[90:91], v[106:107], v[26:27], v[90:91] op_sel:[0,1,0] op_sel_hi:[1,1,1]
    v_pk_fma_f32 v[92:93], v[108:109], v[26:27], v[92:93] op_sel:[0,1,0] op_sel_hi:[1,1,1]
    v_pk_fma_f32 v[94:95], v[110:111], v[26:27], v[94:95] op_sel:[0,1,0] op_sel_hi:[1,1,1]
    v_cvt_pk_bf16_f32 v32, v80, v81
    v_cvt_pk_bf16_f32 v33, v82, v83
    v_cvt_pk_bf16_f32 v34, v84, v85
    v_cvt_pk_bf16_f32 v35, v86, v87
    v_cvt_pk_bf16_f32 v36, v88, v89
    s_add_u32 m0, s25, 150528
    s_add_u32 s3, s83, 21504
    buffer_load_dwordx4 v4, s[36:39], s3 offen lds
    v_cvt_pk_bf16_f32 v37, v90, v91
    v_cvt_pk_bf16_f32 v38, v92, v93
    v_cvt_pk_bf16_f32 v39, v94, v95
    v_cndmask_b32 v38, v38, 0, s[100:101]
    v_cndmask_b32 v39, v39, 0, s[100:101]
    buffer_store_dwordx4 v[32:35], v1, s[56:59], s90 offen sc0 sc1
    buffer_store_dwordx4 v[36:39], v1, s[56:59], s90 offen offset:1024 sc0 sc1
    s_barrier
    buffer_load_dword v53, v52, s[56:59], 0 offen offset:128 sc1
    s_mul_i32 s25, s70, 16384
    s_add_u32 s25, s25, s23
    s_xor_b32 s83, s73, 1
    s_mul_i32 s83, s83, s9
    s_add_u32 s83, s83, s8
    s_add_u32 m0, s25, 49152
    s_add_u32 s3, s83, 0
    buffer_load_dwordx4 v4, s[36:39], s3 offen lds
    s_add_u32 m0, s25, 50176
    s_add_u32 s3, s83, 7168
    buffer_load_dwordx4 v4, s[36:39], s3 offen lds
    s_add_u32 m0, s25, 51200
    s_add_u32 s3, s83, 14336
    buffer_load_dwordx4 v4, s[36:39], s3 offen lds
    s_add_u32 m0, s25, 52224
    s_add_u32 s3, s83, 21504
    buffer_load_dwordx4 v4, s[36:39], s3 offen lds
    s_waitcnt vmcnt(5)
    s_barrier
    buffer_atomic_add v5, v52, s[56:59], 0 offen offset:384 sc1
    s_waitcnt vmcnt(5)
    v_lshrrev_b32 v53, 3, v53
    v_cmp_gt_u32 vcc, v5, v53
    s_cbranch_vccnz R_P1H
B_P1H:
    s_barrier
    s_mul_i32 s26, s70, 16384
    s_add_u32 s26, s26, 81920
    v_add_u32 v8, s26, v7
    v_xor_b32 v9, 64, v8
    ds_read_b64_tr_b16 v[72:73], v8 offset:0
    ds_read_b64_tr_b16 v[74:75], v8 offset:1024
    ds_read_b64_tr_b16 v[76:77], v9 offset:0
    ds_read_b64_tr_b16 v[78:79], v9 offset:1024
    ds_read_b64_tr_b16 v[56:57], v8 offset:2048
    ds_read_b64_tr_b16 v[58:59], v8 offset:3072
    ds_read_b64_tr_b16 v[60:61], v9 offset:2048
    ds_read_b64_tr_b16 v[62:63], v9 offset:3072
    buffer_load_dword v53, v52, s[56:59], 0 offen offset:512 sc1
    s_mul_i32 s84, s72, 49152
    s_add_u32 s84, s84, s14
    s_add_u32 s84, s84, 4096
    buffer_load_dwordx4 v[176:179], v1, s[56:59], s84 offen offset:0 sc1
    buffer_load_dwordx4 v[180:183], v1, s[56:59], s84 offen offset:1024 sc1
    buffer_load_dwordx4 v[184:187], v1, s[56:59], s84 offen offset:2048 sc1
    buffer_load_dwordx4 v[188:191], v1, s[56:59], s84 offen offset:3072 sc1
    s_mul_i32 s84, s72, -49152
    s_add_u32 s84, s84, s14
    s_add_u32 s84, s84, 53248
    buffer_load_dwordx4 v[192:195], v1, s[56:59], s84 offen offset:0 sc1
    buffer_load_dwordx4 v[196:199], v1, s[56:59], s84 offen offset:1024 sc1
    buffer_load_dwordx4 v[200:203], v1, s[56:59], s84 offen offset:2048 sc1
    buffer_load_dwordx4 v[204:207], v1, s[56:59], s84 offen offset:3072 sc1
    s_waitcnt vmcnt(8)
    v_lshrrev_b32 v53, 3, v53
    v_cmp_gt_u32 vcc, v5, v53
    s_cbranch_vccnz R_P4H
B_P4H:
    s_barrier
    ds_read_b64_tr_b16 v[64:65], v8 offset:4096
    ds_read_b64_tr_b16 v[66:67], v8 offset:5120
    s_waitcnt vmcnt(7) lgkmcnt(8)
    v_mfma_f32_32x32x16_bf16 v[112:127], v[72:75], v[176:179], v[112:127]
    s_mov_b32 s84, s15
    buffer_load_dwordx4 v[208:211], v1, s[56:59], s84 offen offset:0 sc1
    ds_read_b64_tr_b16 v[68:69], v9 offset:4096
    ds_read_b64_tr_b16 v[70:71], v9 offset:5120
    s_waitcnt lgkmcnt(8)
    v_mfma_f32_32x32x16_bf16 v[128:143], v[76:79], v[176:179], v[128:143]
    buffer_load_dwordx4 v[212:215], v1, s[56:59], s84 offen offset:1024 sc1
    ds_read_b64_tr_b16 v[72:73], v8 offset:6144
    ds_read_b64_tr_b16 v[74:75], v8 offset:7168
    s_waitcnt vmcnt(8) lgkmcnt(8)
    v_mfma_f32_32x32x16_bf16 v[112:127], v[56:59], v[180:183], v[112:127]
    ds_read_b64_tr_b16 v[76:77], v9 offset:6144
    ds_read_b64_tr_b16 v[78:79], v9 offset:7168
    s_waitcnt lgkmcnt(8)
    v_mfma_f32_32x32x16_bf16 v[128:143], v[60:63], v[180:183], v[128:143]
    buffer_load_dwordx4 v[216:219], v1, s[56:59], s84 offen offset:2048 sc1
    s_mul_i32 s26, s70, 81920
    s_add_u32 s26, s26, 32768
    v_add_u32 v8, s26, v7
    v_xor_b32 v9, 64, v8
    ds_read_b64_tr_b16 v[56:57], v8 offset:0
    ds_read_b64_tr_b16 v[58:59], v8 offset:1024
    s_waitcnt vmcnt(8) lgkmcnt(8)
    v_mfma_f32_32x32x16_bf16 v[112:127], v[64:67], v[184:187], v[112:127]
    ds_read_b64_tr_b16 v[60:61], v9 offset:0
    ds_read_b64_tr_b16 v[62:63], v9 offset:1024
    s_waitcnt lgkmcnt(8)
    v_mfma_f32_32x32x16_bf16 v[128:143], v[68:71], v[184:187], v[128:143]
    buffer_load_dwordx4 v[220:223], v1, s[56:59], s84 offen offset:3072 sc1
    ds_read_b64_tr_b16 v[64:65], v8 offset:2048
    ds_read_b64_tr_b16 v[66:67], v8 offset:3072
    s_waitcnt vmcnt(8) lgkmcnt(8)
    v_mfma_f32_32x32x16_bf16 v[112:127], v[72:75], v[188:191], v[112:127]
    ds_read_b64_tr_b16 v[68:69], v9 offset:2048
    ds_read_b64_tr_b16 v[70:71], v9 offset:3072
    s_waitcnt lgkmcnt(8)
    v_mfma_f32_32x32x16_bf16 v[128:143], v[76:79], v[188:191], v[128:143]
    s_barrier
    s_cmp_eq_u32 s70, 1
    s_cbranch_scc1 KM_VH
    ds_read_b64_tr_b16 v[72:73], v8 offset:4096
    ds_read_b64_tr_b16 v[74:75], v8 offset:5120
    s_waitcnt vmcnt(7) lgkmcnt(8)
    v_mfma_f32_32x32x16_bf16 v[112:127], v[56:59], v[192:195], v[112:127]
    buffer_load_dword v53, v52, s[56:59], 0 offen offset:384 sc1
    ds_read_b64_tr_b16 v[76:77], v9 offset:4096
    ds_read_b64_tr_b16 v[78:79], v9 offset:5120
    s_waitcnt lgkmcnt(8)
    v_mfma_f32_32x32x16_bf16 v[128:143], v[60:63], v[192:195], v[128:143]
    s_mul_i32 s25, s70, 16384
    s_add_u32 s25, s25, s23
    s_xor_b32 s83, s73, 2
    s_mul_i32 s83, s83, s9
    s_add_u32 s83, s83, s8
    s_add_u32 m0, s25, 81920
    s_add_u32 s3, s83, 0
    buffer_load_dwordx4 v4, s[36:39], s3 offen lds
    ds_read_b64_tr_b16 v[56:57], v8 offset:6144
    ds_read_b64_tr_b16 v[58:59], v8 offset:7168
    s_waitcnt vmcnt(8) lgkmcnt(8)
    v_mfma_f32_32x32x16_bf16 v[112:127], v[64:67], v[196:199], v[112:127]
    ds_read_b64_tr_b16 v[60:61], v9 offset:6144
    ds_read_b64_tr_b16 v[62:63], v9 offset:7168
    s_waitcnt lgkmcnt(8)
    v_mfma_f32_32x32x16_bf16 v[128:143], v[68:71], v[196:199], v[128:143]
    s_add_u32 m0, s25, 82944
    s_add_u32 s3, s83, 7168
    buffer_load_dwordx4 v4, s[36:39], s3 offen lds
    s_mul_i32 s26, s70, -131072
    s_add_u32 s26, s26, 131072
    v_add_u32 v8, s26, v7
    v_xor_b32 v9, 64, v8
    ds_read_b64_tr_b16 v[64:65], v8 offset:0
    ds_read_b64_tr_b16 v[66:67], v8 offset:1024
    s_waitcnt vmcnt(8) lgkmcnt(8)
    v_mfma_f32_32x32x16_bf16 v[112:127], v[72:75], v[200:203], v[112:127]
    s_add_u32 m0, s25, 83968
    s_add_u32 s3, s83, 14336
    buffer_load_dwordx4 v4, s[36:39], s3 offen lds
    ds_read_b64_tr_b16 v[68:69], v9 offset:0
    ds_read_b64_tr_b16 v[70:71], v9 offset:1024
    s_waitcnt lgkmcnt(8)
    v_mfma_f32_32x32x16_bf16 v[128:143], v[76:79], v[200:203], v[128:143]
    ds_read_b64_tr_b16 v[72:73], v8 offset:2048
    ds_read_b64_tr_b16 v[74:75], v8 offset:3072
    s_waitcnt vmcnt(8) lgkmcnt(8)
    v_mfma_f32_32x32x16_bf16 v[112:127], v[56:59], v[204:207], v[112:127]
    s_add_u32 m0, s25, 84992
    s_add_u32 s3, s83, 21504
    buffer_load_dwordx4 v4, s[36:39], s3 offen lds
    ds_read_b64_tr_b16 v[76:77], v9 offset:2048
    ds_read_b64_tr_b16 v[78:79], v9 offset:3072
    s_waitcnt lgkmcnt(8)
    v_mfma_f32_32x32x16_bf16 v[128:143], v[60:63], v[204:207], v[128:143]
    s_waitcnt vmcnt(4)
    v_lshrrev_b32 v53, 3, v53
    v_cmp_gt_u32 vcc, v5, v53
    s_cbranch_vccnz R_P3H
B_P3H:
    s_barrier
    ds_read_b64_tr_b16 v[56:57], v8 offset:4096
    ds_read_b64_tr_b16 v[58:59], v8 offset:5120
    s_waitcnt lgkmcnt(8)
    v_mfma_f32_32x32x16_bf16 v[112:127], v[64:67], v[208:211], v[112:127]
    s_mul_i32 s25, s70, 81920
    s_add_u32 s25, s25, s23
    s_xor_b32 s83, s73, 3
    s_mul_i32 s83, s83, s9
    s_add_u32 s83, s83, s8
    s_add_u32 m0, s25, 32768
    s_add_u32 s3, s83, 0
    buffer_load_dwordx4 v4, s[36:39], s3 offen lds
    s_add_u32 m0, s25, 33792
    s_add_u32 s3, s83, 7168
    buffer_load_dwordx4 v4, s[36:39], s3 offen lds
    ds_read_b64_tr_b16 v[60:61], v9 offset:4096
    ds_read_b64_tr_b16 v[62:63], v9 offset:5120
    s_waitcnt lgkmcnt(8)
    v_mfma_f32_32x32x16_bf16 v[128:143], v[68:71], v[208:211], v[128:143]
    s_add_u32 m0, s25, 34816
    s_add_u32 s3, s83, 14336
    buffer_load_dwordx4 v4, s[36:39], s3 offen lds
    ds_read_b64_tr_b16 v[64:65], v8 offset:6144
    ds_read_b64_tr_b16 v[66:67], v8 offset:7168
    s_waitcnt lgkmcnt(8)
    v_mfma_f32_32x32x16_bf16 v[112:127], v[72:75], v[212:215], v[112:127]
    s_add_u32 m0, s25, 35840
    s_add_u32 s3, s83, 21504
    buffer_load_dwordx4 v4, s[36:39], s3 offen lds
    s_xor_b32 s84, s73, 0
    s_mul_i32 s84, s84, s17
    s_add_u32 s84, s84, s16
    buffer_load_dwordx4 v[224:227], v1, s[56:59], s84 offen offset:0 sc1
    ds_read_b64_tr_b16 v[68:69], v9 offset:6144
    ds_read_b64_tr_b16 v[70:71], v9 offset:7168
    s_waitcnt lgkmcnt(8)
    v_mfma_f32_32x32x16_bf16 v[128:143], v[76:79], v[212:215], v[128:143]
    buffer_load_dwordx4 v[228:231], v1, s[56:59], s84 offen offset:1024 sc1
    s_waitcnt lgkmcnt(6)
    v_mfma_f32_32x32x16_bf16 v[112:127], v[56:59], v[216:219], v[112:127]
    buffer_load_dwordx4 v[232:235], v1, s[56:59], s84 offen offset:2048 sc1
    buffer_load_dwordx4 v[236:239], v1, s[56:59], s84 offen offset:3072 sc1
    s_waitcnt lgkmcnt(4)
    v_mfma_f32_32x32x16_bf16 v[128:143], v[60:63], v[216:219], v[128:143]
    s_xor_b32 s84, s73, 1
    s_mul_i32 s84, s84, s17
    s_add_u32 s84, s84, s16
    buffer_load_dwordx4 v[240:243], v1, s[56:59], s84 offen offset:0 sc1
    s_waitcnt lgkmcnt(2)
    v_mfma_f32_32x32x16_bf16 v[112:127], v[64:67], v[220:223], v[112:127]
    buffer_load_dwordx4 v[244:247], v1, s[56:59], s84 offen offset:1024 sc1
    buffer_load_dwordx4 v[248:251], v1, s[56:59], s84 offen offset:2048 sc1
    s_waitcnt lgkmcnt(0)
    v_mfma_f32_32x32x16_bf16 v[128:143], v[68:71], v[220:223], v[128:143]
    buffer_load_dwordx4 v[252:255], v1, s[56:59], s84 offen offset:3072 sc1
    s_barrier
    v_add_u32 v32, 147456, v7
    v_xor_b32 v33, 64, v32
    v_add_u32 v34, 49152, v7
    v_xor_b32 v35, 64, v34
    s_bitcmp1_b32 s68, 1
    s_cselect_b32 s26, 0, 8
    s_lshl_b32 s26, s26, 14
    v_add_u32 v15, s26, v20
    v_xor_b32 v16, 32, v15
    v_xor_b32 v17, 64, v15
    v_xor_b32 v18, 96, v15
    ds_read_b64_tr_b16 v[56:57], v32 offset:0
    ds_read_b64_tr_b16 v[58:59], v32 offset:1024
    ds_read_b64_tr_b16 v[60:61], v33 offset:0
    ds_read_b64_tr_b16 v[62:63], v33 offset:1024
    ds_read_b64_tr_b16 v[64:65], v32 offset:2048
    ds_read_b64_tr_b16 v[66:67], v32 offset:3072
    ds_read_b64_tr_b16 v[68:69], v33 offset:2048
    ds_read_b64_tr_b16 v[70:71], v33 offset:3072
    s_waitcnt vmcnt(7) lgkmcnt(6)
    v_mfma_f32_32x32x16_bf16 v[80:95], v[56:59], v[224:227], 0
    s_xor_b32 s84, s73, 2
    s_mul_i32 s84, s84, s17
    s_add_u32 s84, s84, s16
    buffer_load_dwordx4 v[144:147], v1, s[56:59], s84 offen offset:0 sc1
    ds_read_b64_tr_b16 v[176:177], v32 offset:4096
    ds_read_b64_tr_b16 v[178:179], v32 offset:5120
    ds_read_b64_tr_b16 v[180:181], v33 offset:4096
    ds_read_b64_tr_b16 v[182:183], v33 offset:5120
    s_waitcnt lgkmcnt(8)
    v_mfma_f32_32x32x16_bf16 v[96:111], v[60:63], v[224:227], 0
    buffer_load_dwordx4 v[148:151], v1, s[56:59], s84 offen offset:1024 sc1
    ds_read_b64_tr_b16 v[184:185], v32 offset:6144
    ds_read_b64_tr_b16 v[186:187], v32 offset:7168
    ds_read_b64_tr_b16 v[188:189], v33 offset:6144
    ds_read_b64_tr_b16 v[190:191], v33 offset:7168
    s_waitcnt vmcnt(8) lgkmcnt(10)
    v_mfma_f32_32x32x16_bf16 v[80:95], v[64:67], v[228:231], v[80:95]
    buffer_load_dwordx4 v[152:155], v1, s[56:59], s84 offen offset:2048 sc1
    ds_read_b64_tr_b16 v[192:193], v34 offset:0
    ds_read_b64_tr_b16 v[194:195], v34 offset:1024
    ds_read_b64_tr_b16 v[196:197], v35 offset:0
    ds_read_b64_tr_b16 v[198:199], v35 offset:1024
    s_waitcnt lgkmcnt(12)
    v_mfma_f32_32x32x16_bf16 v[96:111], v[68:71], v[228:231], v[96:111]
    buffer_load_dwordx4 v[156:159], v1, s[56:59], s84 offen offset:3072 sc1
    ds_read_b64_tr_b16 v[200:201], v34 offset:2048
    ds_read_b64_tr_b16 v[202:203], v34 offset:3072
    ds_read_b64_tr_b16 v[204:205], v35 offset:2048
    ds_read_b64_tr_b16 v[206:207], v35 offset:3072
    s_waitcnt vmcnt(9) lgkmcnt(14)
    v_mfma_f32_32x32x16_bf16 v[80:95], v[176:179], v[232:235], v[80:95]
    ds_read_b64_tr_b16 v[208:209], v34 offset:4096
    ds_read_b64_tr_b16 v[210:211], v34 offset:5120
    ds_read_b64_tr_b16 v[212:213], v35 offset:4096
    ds_read_b64_tr_b16 v[214:215], v35 offset:5120
    s_waitcnt lgkmcnt(15)
    v_mfma_f32_32x32x16_bf16 v[96:111], v[180:183], v[232:235], v[96:111]
    s_xor_b32 s84, s73, 3
    s_mul_i32 s84, s84, s17
    s_add_u32 s84, s84, s16
    buffer_load_dwordx4 v[160:163], v1, s[56:59], s84 offen offset:0 sc1
    ds_read_b64_tr_b16 v[216:217], v34 offset:6144
    ds_read_b64_tr_b16 v[218:219], v34 offset:7168
    ds_read_b64_tr_b16 v[220:221], v35 offset:6144
    ds_read_b64_tr_b16 v[222:223], v35 offset:7168
    s_waitcnt vmcnt(9) lgkmcnt(15)
    v_mfma_f32_32x32x16_bf16 v[80:95], v[184:187], v[236:239], v[80:95]
    buffer_load_dwordx4 v[164:167], v1, s[56:59], s84 offen offset:1024 sc1
    s_waitcnt lgkmcnt(15)
    v_mfma_f32_32x32x16_bf16 v[96:111], v[188:191], v[236:239], v[96:111]
    buffer_load_dwordx4 v[168:171], v1, s[56:59], s84 offen offset:2048 sc1
    s_waitcnt vmcnt(10) lgkmcnt(14)
    v_mfma_f32_32x32x16_bf16 v[80:95], v[192:195], v[240:243], v[80:95]
    ds_write_b128 v15, v[112:115] offset:0
    s_waitcnt lgkmcnt(13)
    v_mfma_f32_32x32x16_bf16 v[96:111], v[196:199], v[240:243], v[96:111]
    buffer_load_dwordx4 v[172:175], v1, s[56:59], s84 offen offset:3072 sc1
    ds_write_b128 v16, v[116:119] offset:0
    s_waitcnt vmcnt(10) lgkmcnt(12)
    v_mfma_f32_32x32x16_bf16 v[80:95], v[200:203], v[244:247], v[80:95]
    buffer_load_dwordx4 v[22:25], v21, s[28:31], 0 offen
    ds_write_b128 v17, v[120:123] offset:0
    s_waitcnt lgkmcnt(11)
    v_mfma_f32_32x32x16_bf16 v[96:111], v[204:207], v[244:247], v[96:111]
    ds_write_b128 v18, v[124:127] offset:0
    s_waitcnt vmcnt(10) lgkmcnt(10)
    v_mfma_f32_32x32x16_bf16 v[80:95], v[208:211], v[248:251], v[80:95]
    ds_write_b128 v15, v[128:131] offset:128
    s_waitcnt lgkmcnt(9)
    v_mfma_f32_32x32x16_bf16 v[96:111], v[212:215], v[248:251], v[96:111]
    ds_write_b128 v16, v[132:135] offset:128
    s_waitcnt vmcnt(9) lgkmcnt(8)
    v_mfma_f32_32x32x16_bf16 v[80:95], v[216:219], v[252:255], v[80:95]
    ds_write_b128 v17, v[136:139] offset:128
    s_waitcnt lgkmcnt(7)
    v_mfma_f32_32x32x16_bf16 v[96:111], v[220:223], v[252:255], v[96:111]
    ds_write_b128 v18, v[140:143] offset:128
    s_waitcnt lgkmcnt(0)
    s_barrier
    v_add_u32 v36, 81920, v7
    v_xor_b32 v37, 64, v36
    v_add_u32 v38, 32768, v7
    v_xor_b32 v39, 64, v38
    s_bitcmp1_b32 s68, 1
    s_cselect_b32 s26, 3, 9
    s_lshl_b32 s26, s26, 14
    v_add_u32 v15, s26, v20
    v_xor_b32 v16, 32, v15
    v_xor_b32 v17, 64, v15
    v_xor_b32 v18, 96, v15
    ds_read_b64_tr_b16 v[56:57], v36 offset:0
    ds_read_b64_tr_b16 v[58:59], v36 offset:1024
    ds_read_b64_tr_b16 v[60:61], v36 offset:2048
    ds_read_b64_tr_b16 v[62:63], v36 offset:3072
    ds_read_b64_tr_b16 v[64:65], v36 offset:4096
    ds_read_b64_tr_b16 v[66:67], v36 offset:5120
    ds_read_b64_tr_b16 v[68:69], v36 offset:6144
    ds_read_b64_tr_b16 v[70:71], v36 offset:7168
    s_waitcnt vmcnt(8) lgkmcnt(6)
    v_mfma_f32_32x32x16_bf16 v[80:95], v[56:59], v[144:147], v[80:95]
    ds_read_b64_tr_b16 v[176:177], v38 offset:0
    ds_read_b64_tr_b16 v[178:179], v38 offset:1024
    ds_read_b64_tr_b16 v[180:181], v38 offset:2048
    ds_read_b64_tr_b16 v[182:183], v38 offset:3072
    s_waitcnt vmcnt(7) lgkmcnt(8)
    v_mfma_f32_32x32x16_bf16 v[80:95], v[60:63], v[148:151], v[80:95]
    ds_read_b64_tr_b16 v[184:185], v38 offset:4096
    ds_read_b64_tr_b16 v[186:187], v38 offset:5120
    ds_read_b64_tr_b16 v[188:189], v38 offset:6144
    ds_read_b64_tr_b16 v[190:191], v38 offset:7168
    s_waitcnt vmcnt(6) lgkmcnt(10)
    v_mfma_f32_32x32x16_bf16 v[80:95], v[64:67], v[152:155], v[80:95]
    ds_read_b64_tr_b16 v[192:193], v37 offset:0
    ds_read_b64_tr_b16 v[194:195], v37 offset:1024
    ds_read_b64_tr_b16 v[196:197], v37 offset:2048
    ds_read_b64_tr_b16 v[198:199], v37 offset:3072
    s_waitcnt vmcnt(5) lgkmcnt(12)
    v_mfma_f32_32x32x16_bf16 v[80:95], v[68:71], v[156:159], v[80:95]
    ds_read_b64_tr_b16 v[200:201], v37 offset:4096
    ds_read_b64_tr_b16 v[202:203], v37 offset:5120
    ds_read_b64_tr_b16 v[204:205], v37 offset:6144
    ds_read_b64_tr_b16 v[206:207], v37 offset:7168
    s_waitcnt vmcnt(4) lgkmcnt(14)
    v_mfma_f32_32x32x16_bf16 v[80:95], v[176:179], v[160:163], v[80:95]
    ds_read_b64_tr_b16 v[208:209], v39 offset:0
    ds_read_b64_tr_b16 v[210:211], v39 offset:1024
    ds_read_b64_tr_b16 v[212:213], v39 offset:2048
    ds_read_b64_tr_b16 v[214:215], v39 offset:3072
    s_waitcnt vmcnt(3) lgkmcnt(15)
    v_mfma_f32_32x32x16_bf16 v[80:95], v[180:183], v[164:167], v[80:95]
    ds_read_b64_tr_b16 v[216:217], v39 offset:4096
    ds_read_b64_tr_b16 v[218:219], v39 offset:5120
    ds_read_b64_tr_b16 v[220:221], v39 offset:6144
    ds_read_b64_tr_b16 v[222:223], v39 offset:7168
    s_waitcnt vmcnt(2) lgkmcnt(15)
    v_mfma_f32_32x32x16_bf16 v[80:95], v[184:187], v[168:171], v[80:95]
    s_waitcnt vmcnt(1) lgkmcnt(15)
    v_mfma_f32_32x32x16_bf16 v[80:95], v[188:191], v[172:175], v[80:95]
    s_waitcnt lgkmcnt(14)
    v_mfma_f32_32x32x16_bf16 v[96:111], v[192:195], v[144:147], v[96:111]
    s_waitcnt lgkmcnt(12)
    v_mfma_f32_32x32x16_bf16 v[96:111], v[196:199], v[148:151], v[96:111]
    s_waitcnt lgkmcnt(10)
    v_mfma_f32_32x32x16_bf16 v[96:111], v[200:203], v[152:155], v[96:111]
    s_nop 5
    ds_write_b128 v15, v[80:83] offset:0
    s_waitcnt lgkmcnt(9)
    v_mfma_f32_32x32x16_bf16 v[96:111], v[204:207], v[156:159], v[96:111]
    ds_write_b128 v16, v[84:87] offset:0
    s_waitcnt lgkmcnt(8)
    v_mfma_f32_32x32x16_bf16 v[96:111], v[208:211], v[160:163], v[96:111]
    ds_write_b128 v17, v[88:91] offset:0
    s_waitcnt lgkmcnt(7)
    v_mfma_f32_32x32x16_bf16 v[96:111], v[212:215], v[164:167], v[96:111]
    ds_write_b128 v18, v[92:95] offset:0
    s_waitcnt lgkmcnt(6)
    v_mfma_f32_32x32x16_bf16 v[96:111], v[216:219], v[168:171], v[96:111]
    s_waitcnt lgkmcnt(4)
    v_mfma_f32_32x32x16_bf16 v[96:111], v[220:223], v[172:175], v[96:111]
    v_add_u32 v32, 131072, v19
    v_xor_b32 v33, 16, v32
    v_add_u32 v34, 0, v19
    v_xor_b32 v35, 16, v34
    v_add_u32 v36, 16384, v19
    v_xor_b32 v37, 16, v36
    v_add_u32 v38, 65536, v19
    v_xor_b32 v39, 16, v38
    s_nop 3
    ds_write_b128 v15, v[96:99] offset:128
    ds_write_b128 v16, v[100:103] offset:128
    ds_write_b128 v17, v[104:107] offset:128
    ds_write_b128 v18, v[108:111] offset:128
    v_add_u32 v40, 147456, v19
    v_xor_b32 v41, 16, v40
    v_add_u32 v42, 49152, v19
    v_xor_b32 v43, 16, v42
    v_mov_b32 v30, 0xbfb8aa3b
    v_mov_b32 v31, 1.0
    s_waitcnt vmcnt(0)
    v_lshlrev_b32 v184, 16, v22
    v_and_b32 v185, 0xffff0000, v22
    v_lshlrev_b32 v186, 16, v23
    v_and_b32 v187, 0xffff0000, v23
    v_lshlrev_b32 v188, 16, v24
    v_and_b32 v189, 0xffff0000, v24
    v_lshlrev_b32 v190, 16, v25
    v_and_b32 v191, 0xffff0000, v25
    s_waitcnt lgkmcnt(0)
    s_barrier
    ds_read_b128 v[176:179], v32
    ds_read_b128 v[180:183], v33
    ds_read_b128 v[224:227], v34
    ds_read_b128 v[228:231], v35
    ds_read_b128 v[208:211], v36
    ds_read_b128 v[212:215], v37
    ds_read_b128 v[216:219], v38
    ds_read_b128 v[220:223], v39
    ds_read_b128 v[192:195], v40
    ds_read_b128 v[196:199], v41
    ds_read_b128 v[200:203], v42
    ds_read_b128 v[204:207], v43
    s_waitcnt lgkmcnt(9)
    v_pk_add_f32 v[176:177], v[176:177], v[224:225]
    v_pk_add_f32 v[178:179], v[178:179], v[226:227]
    s_waitcnt lgkmcnt(8)
    v_pk_add_f32 v[180:181], v[180:181], v[228:229]
    v_pk_add_f32 v[182:183], v[182:183], v[230:231]
    s_waitcnt lgkmcnt(5)
    v_pk_add_f32 v[208:209], v[208:209], v[216:217]
    v_pk_add_f32 v[210:211], v[210:211], v[218:219]
    s_waitcnt lgkmcnt(4)
    v_pk_add_f32 v[212:213], v[212:213], v[220:221]
    v_pk_add_f32 v[214:215], v[214:215], v[222:223]
    v_pk_add_f32 v[176:177], v[176:177], v[208:209]
    v_pk_add_f32 v[178:179], v[178:179], v[210:211]
    v_pk_add_f32 v[180:181], v[180:181], v[212:213]
    v_pk_add_f32 v[182:183], v[182:183], v[214:215]
    v_pk_mul_f32 v[208:209], v[176:177], v[30:31] op_sel_hi:[1,0]
    v_pk_mul_f32 v[210:211], v[178:179], v[30:31] op_sel_hi:[1,0]
    v_pk_mul_f32 v[212:213], v[180:181], v[30:31] op_sel_hi:[1,0]
    v_pk_mul_f32 v[214:215], v[182:183], v[30:31] op_sel_hi:[1,0]
    v_exp_f32 v208, v208
    v_exp_f32 v209, v209
    s_waitcnt lgkmcnt(1)
    v_pk_add_f32 v[192:193], v[192:193], v[200:201]
    v_exp_f32 v210, v210
    v_exp_f32 v211, v211
    v_pk_add_f32 v[194:195], v[194:195], v[202:203]
    v_exp_f32 v212, v212
    v_exp_f32 v213, v213
    s_waitcnt lgkmcnt(0)
    v_pk_add_f32 v[196:197], v[196:197], v[204:205]
    v_exp_f32 v214, v214
    v_exp_f32 v215, v215
    v_pk_add_f32 v[198:199], v[198:199], v[206:207]
    v_pk_add_f32 v[208:209], v[208:209], v[30:31] op_sel:[0,1] op_sel_hi:[1,1]
    v_pk_add_f32 v[210:211], v[210:211], v[30:31] op_sel:[0,1] op_sel_hi:[1,1]
    v_pk_add_f32 v[212:213], v[212:213], v[30:31] op_sel:[0,1] op_sel_hi:[1,1]
    v_pk_add_f32 v[214:215], v[214:215], v[30:31] op_sel:[0,1] op_sel_hi:[1,1]
    v_rcp_f32 v208, v208
    v_rcp_f32 v209, v209
    v_pk_mul_f32 v[176:177], v[176:177], v[192:193]
    v_rcp_f32 v210, v210
    v_rcp_f32 v211, v211
    v_pk_mul_f32 v[178:179], v[178:179], v[194:195]
    v_rcp_f32 v212, v212
    v_rcp_f32 v213, v213
    v_pk_mul_f32 v[180:181], v[180:181], v[196:197]
    v_rcp_f32 v214, v214
    v_rcp_f32 v215, v215
    v_pk_mul_f32 v[182:183], v[182:183], v[198:199]
    v_pk_fma_f32 v[184:185], v[208:209], v[176:177], v[184:185]
    v_pk_fma_f32 v[186:187], v[210:211], v[178:179], v[186:187]
    v_pk_fma_f32 v[188:189], v[212:213], v[180:181], v[188:189]
    v_pk_fma_f32 v[190:191], v[214:215], v[182:183], v[190:191]
    v_cvt_pk_bf16_f32 v22, v184, v185
    v_cvt_pk_bf16_f32 v23, v186, v187
    v_cvt_pk_bf16_f32 v24, v188, v189
    v_cvt_pk_bf16_f32 v25, v190, v191
    buffer_store_dwordx4 v[22:25], v21, s[64:67], 0 offen sc0 sc1
    s_endpgm
KM_VH:
    s_lshl_b32 s3, s71, 10
    s_add_u32 s3, s3, 12648448
    v_mov_b32 v2, s3
    v_mov_b32 v3, 0x7ff00000
    v_cmp_eq_u32 vcc, 256, v0
    s_nop 1
    v_cndmask_b32 v2, v3, v2, vcc
    v_cndmask_b32 v3, 0, 1, vcc
    ds_read_b64_tr_b16 v[72:73], v8 offset:4096
    ds_read_b64_tr_b16 v[74:75], v8 offset:5120
    s_waitcnt vmcnt(7) lgkmcnt(8)
    v_mfma_f32_32x32x16_bf16 v[112:127], v[56:59], v[192:195], v[112:127]
    buffer_load_dword v53, v2, s[56:59], 0 offen offset:256 sc1
    ds_read_b64_tr_b16 v[76:77], v9 offset:4096
    ds_read_b64_tr_b16 v[78:79], v9 offset:5120
    s_waitcnt lgkmcnt(8)
    v_mfma_f32_32x32x16_bf16 v[128:143], v[60:63], v[192:195], v[128:143]
    s_mul_i32 s25, s70, 16384
    s_add_u32 s25, s25, s23
    s_xor_b32 s83, s73, 2
    s_mul_i32 s83, s83, s9
    s_add_u32 s83, s83, s8
    s_add_u32 m0, s25, 81920
    s_add_u32 s3, s83, 0
    buffer_load_dwordx4 v4, s[36:39], s3 offen lds
    ds_read_b64_tr_b16 v[56:57], v8 offset:6144
    ds_read_b64_tr_b16 v[58:59], v8 offset:7168
    s_waitcnt vmcnt(8) lgkmcnt(8)
    v_mfma_f32_32x32x16_bf16 v[112:127], v[64:67], v[196:199], v[112:127]
    ds_read_b64_tr_b16 v[60:61], v9 offset:6144
    ds_read_b64_tr_b16 v[62:63], v9 offset:7168
    s_waitcnt lgkmcnt(8)
    v_mfma_f32_32x32x16_bf16 v[128:143], v[68:71], v[196:199], v[128:143]
    s_add_u32 m0, s25, 82944
    s_add_u32 s3, s83, 7168
    buffer_load_dwordx4 v4, s[36:39], s3 offen lds
    s_mul_i32 s26, s70, -131072
    s_add_u32 s26, s26, 131072
    v_add_u32 v8, s26, v7
    v_xor_b32 v9, 64, v8
    ds_read_b64_tr_b16 v[64:65], v8 offset:0
    ds_read_b64_tr_b16 v[66:67], v8 offset:1024
    s_waitcnt vmcnt(8) lgkmcnt(8)
    v_mfma_f32_32x32x16_bf16 v[112:127], v[72:75], v[200:203], v[112:127]
    s_add_u32 m0, s25, 83968
    s_add_u32 s3, s83, 14336
    buffer_load_dwordx4 v4, s[36:39], s3 offen lds
    ds_read_b64_tr_b16 v[68:69], v9 offset:0
    ds_read_b64_tr_b16 v[70:71], v9 offset:1024
    s_waitcnt lgkmcnt(8)
    v_mfma_f32_32x32x16_bf16 v[128:143], v[76:79], v[200:203], v[128:143]
    ds_read_b64_tr_b16 v[72:73], v8 offset:2048
    ds_read_b64_tr_b16 v[74:75], v8 offset:3072
    s_waitcnt vmcnt(8) lgkmcnt(8)
    v_mfma_f32_32x32x16_bf16 v[112:127], v[56:59], v[204:207], v[112:127]
    s_add_u32 m0, s25, 84992
    s_add_u32 s3, s83, 21504
    buffer_load_dwordx4 v4, s[36:39], s3 offen lds
    ds_read_b64_tr_b16 v[76:77], v9 offset:2048
    ds_read_b64_tr_b16 v[78:79], v9 offset:3072
    s_waitcnt lgkmcnt(8)
    v_mfma_f32_32x32x16_bf16 v[128:143], v[60:63], v[204:207], v[128:143]
    s_waitcnt vmcnt(4)
    v_lshrrev_b32 v53, 3, v53
    v_cmp_gt_u32 vcc, v3, v53
    s_cbranch_vccnz R_P2H
B_P2H:
    s_barrier
    ds_read_b64_tr_b16 v[56:57], v8 offset:4096
    ds_read_b64_tr_b16 v[58:59], v8 offset:5120
    s_waitcnt lgkmcnt(8)
    v_mfma_f32_32x32x16_bf16 v[112:127], v[64:67], v[208:211], v[112:127]
    s_mul_i32 s25, s70, 81920
    s_add_u32 s25, s25, s23
    s_xor_b32 s83, s73, 3
    s_mul_i32 s83, s83, s9
    s_add_u32 s83, s83, s8
    s_add_u32 m0, s25, 32768
    s_add_u32 s3, s83, 0
    buffer_load_dwordx4 v4, s[36:39], s3 offen lds
    s_add_u32 m0, s25, 33792
    s_add_u32 s3, s83, 7168
    buffer_load_dwordx4 v4, s[36:39], s3 offen lds
    ds_read_b64_tr_b16 v[60:61], v9 offset:4096
    ds_read_b64_tr_b16 v[62:63], v9 offset:5120
    s_waitcnt lgkmcnt(8)
    v_mfma_f32_32x32x16_bf16 v[128:143], v[68:71], v[208:211], v[128:143]
    s_add_u32 m0, s25, 34816
    s_add_u32 s3, s83, 14336
    buffer_load_dwordx4 v4, s[36:39], s3 offen lds
    ds_read_b64_tr_b16 v[64:65], v8 offset:6144
    ds_read_b64_tr_b16 v[66:67], v8 offset:7168
    s_waitcnt lgkmcnt(8)
    v_mfma_f32_32x32x16_bf16 v[112:127], v[72:75], v[212:215], v[112:127]
    s_add_u32 m0, s25, 35840
    s_add_u32 s3, s83, 21504
    buffer_load_dwordx4 v4, s[36:39], s3 offen lds
    s_xor_b32 s84, s73, 0
    s_mul_i32 s84, s84, s17
    s_add_u32 s84, s84, s16
    buffer_load_dwordx4 v[224:227], v1, s[56:59], s84 offen offset:0 sc1
    ds_read_b64_tr_b16 v[68:69], v9 offset:6144
    ds_read_b64_tr_b16 v[70:71], v9 offset:7168
    s_waitcnt lgkmcnt(8)
    v_mfma_f32_32x32x16_bf16 v[128:143], v[76:79], v[212:215], v[128:143]
    buffer_load_dwordx4 v[228:231], v1, s[56:59], s84 offen offset:1024 sc1
    s_waitcnt lgkmcnt(6)
    v_mfma_f32_32x32x16_bf16 v[112:127], v[56:59], v[216:219], v[112:127]
    buffer_load_dwordx4 v[232:235], v1, s[56:59], s84 offen offset:2048 sc1
    buffer_load_dwordx4 v[236:239], v1, s[56:59], s84 offen offset:3072 sc1
    s_waitcnt lgkmcnt(4)
    v_mfma_f32_32x32x16_bf16 v[128:143], v[60:63], v[216:219], v[128:143]
    s_xor_b32 s84, s73, 1
    s_mul_i32 s84, s84, s17
    s_add_u32 s84, s84, s16
    buffer_load_dwordx4 v[240:243], v1, s[56:59], s84 offen offset:0 sc1
    s_waitcnt lgkmcnt(2)
    v_mfma_f32_32x32x16_bf16 v[112:127], v[64:67], v[220:223], v[112:127]
    buffer_load_dwordx4 v[244:247], v1, s[56:59], s84 offen offset:1024 sc1
    buffer_load_dwordx4 v[248:251], v1, s[56:59], s84 offen offset:2048 sc1
    s_waitcnt lgkmcnt(0)
    v_mfma_f32_32x32x16_bf16 v[128:143], v[68:71], v[220:223], v[128:143]
    buffer_load_dwordx4 v[252:255], v1, s[56:59], s84 offen offset:3072 sc1
    s_barrier
    v_add_u32 v32, 16384, v7
    v_xor_b32 v33, 64, v32
    v_add_u32 v34, 65536, v7
    v_xor_b32 v35, 64, v34
    s_setprio 2
    ds_read_b64_tr_b16 v[56:57], v32 offset:0
    ds_read_b64_tr_b16 v[58:59], v32 offset:1024
    ds_read_b64_tr_b16 v[60:61], v33 offset:0
    ds_read_b64_tr_b16 v[62:63], v33 offset:1024
    ds_read_b64_tr_b16 v[64:65], v32 offset:2048
    ds_read_b64_tr_b16 v[66:67], v32 offset:3072
    ds_read_b64_tr_b16 v[68:69], v33 offset:2048
    ds_read_b64_tr_b16 v[70:71], v33 offset:3072
    ds_read_b64_tr_b16 v[176:177], v32 offset:4096
    ds_read_b64_tr_b16 v[178:179], v32 offset:5120
    ds_read_b64_tr_b16 v[180:181], v33 offset:4096
    ds_read_b64_tr_b16 v[182:183], v33 offset:5120
    s_waitcnt vmcnt(7) lgkmcnt(10)
    v_mfma_f32_32x32x16_bf16 v[112:127], v[56:59], v[224:227], v[112:127]
    s_xor_b32 s84, s73, 2
    s_mul_i32 s84, s84, s17
    s_add_u32 s84, s84, s16
    buffer_load_dwordx4 v[144:147], v1, s[56:59], s84 offen offset:0 sc1
    ds_read_b64_tr_b16 v[184:185], v32 offset:6144
    ds_read_b64_tr_b16 v[186:187], v32 offset:7168
    ds_read_b64_tr_b16 v[188:189], v33 offset:6144
    ds_read_b64_tr_b16 v[190:191], v33 offset:7168
    s_waitcnt lgkmcnt(12)
    v_mfma_f32_32x32x16_bf16 v[128:143], v[60:63], v[224:227], v[128:143]
    buffer_load_dwordx4 v[148:151], v1, s[56:59], s84 offen offset:1024 sc1
    ds_read_b64_tr_b16 v[192:193], v34 offset:0
    ds_read_b64_tr_b16 v[194:195], v34 offset:1024
    ds_read_b64_tr_b16 v[196:197], v35 offset:0
    ds_read_b64_tr_b16 v[198:199], v35 offset:1024
    s_waitcnt vmcnt(8) lgkmcnt(14)
    v_mfma_f32_32x32x16_bf16 v[112:127], v[64:67], v[228:231], v[112:127]
    buffer_load_dwordx4 v[152:155], v1, s[56:59], s84 offen offset:2048 sc1
    ds_read_b64_tr_b16 v[200:201], v34 offset:2048
    ds_read_b64_tr_b16 v[202:203], v34 offset:3072
    ds_read_b64_tr_b16 v[204:205], v35 offset:2048
    ds_read_b64_tr_b16 v[206:207], v35 offset:3072
    s_waitcnt lgkmcnt(15)
    v_mfma_f32_32x32x16_bf16 v[128:143], v[68:71], v[228:231], v[128:143]
    buffer_load_dwordx4 v[156:159], v1, s[56:59], s84 offen offset:3072 sc1
    ds_read_b64_tr_b16 v[208:209], v34 offset:4096
    ds_read_b64_tr_b16 v[210:211], v34 offset:5120
    ds_read_b64_tr_b16 v[212:213], v35 offset:4096
    ds_read_b64_tr_b16 v[214:215], v35 offset:5120
    s_waitcnt vmcnt(9) lgkmcnt(15)
    v_mfma_f32_32x32x16_bf16 v[112:127], v[176:179], v[232:235], v[112:127]
    ds_read_b64_tr_b16 v[216:217], v34 offset:6144
    ds_read_b64_tr_b16 v[218:219], v34 offset:7168
    ds_read_b64_tr_b16 v[220:221], v35 offset:6144
    ds_read_b64_tr_b16 v[222:223], v35 offset:7168
    s_setprio 0
    s_waitcnt lgkmcnt(15)
    v_mfma_f32_32x32x16_bf16 v[128:143], v[180:183], v[232:235], v[128:143]
    s_xor_b32 s84, s73, 3
    s_mul_i32 s84, s84, s17
    s_add_u32 s84, s84, s16
    buffer_load_dwordx4 v[160:163], v1, s[56:59], s84 offen offset:0 sc1
    s_waitcnt vmcnt(9) lgkmcnt(15)
    v_mfma_f32_32x32x16_bf16 v[112:127], v[184:187], v[236:239], v[112:127]
    buffer_load_dwordx4 v[164:167], v1, s[56:59], s84 offen offset:1024 sc1
    s_waitcnt lgkmcnt(15)
    v_mfma_f32_32x32x16_bf16 v[128:143], v[188:191], v[236:239], v[128:143]
    buffer_load_dwordx4 v[168:171], v1, s[56:59], s84 offen offset:2048 sc1
    s_waitcnt vmcnt(10) lgkmcnt(14)
    v_mfma_f32_32x32x16_bf16 v[112:127], v[192:195], v[240:243], v[112:127]
    s_waitcnt lgkmcnt(12)
    v_mfma_f32_32x32x16_bf16 v[128:143], v[196:199], v[240:243], v[128:143]
    buffer_load_dwordx4 v[172:175], v1, s[56:59], s84 offen offset:3072 sc1
    s_waitcnt vmcnt(10) lgkmcnt(10)
    v_mfma_f32_32x32x16_bf16 v[112:127], v[200:203], v[244:247], v[112:127]
    buffer_load_dwordx4 v[22:25], v21, s[28:31], 0 offen
    s_waitcnt lgkmcnt(8)
    v_mfma_f32_32x32x16_bf16 v[128:143], v[204:207], v[244:247], v[128:143]
    s_waitcnt vmcnt(10) lgkmcnt(6)
    v_mfma_f32_32x32x16_bf16 v[112:127], v[208:211], v[248:251], v[112:127]
    s_waitcnt lgkmcnt(4)
    v_mfma_f32_32x32x16_bf16 v[128:143], v[212:215], v[248:251], v[128:143]
    s_waitcnt vmcnt(9) lgkmcnt(2)
    v_mfma_f32_32x32x16_bf16 v[112:127], v[216:219], v[252:255], v[112:127]
    s_waitcnt lgkmcnt(0)
    v_mfma_f32_32x32x16_bf16 v[128:143], v[220:223], v[252:255], v[128:143]
    s_barrier
    v_add_u32 v36, 98304, v7
    v_xor_b32 v37, 64, v36
    v_add_u32 v38, 114688, v7
    v_xor_b32 v39, 64, v38
    s_bitcmp1_b32 s68, 1
    s_cselect_b32 s26, 4, 1
    s_lshl_b32 s26, s26, 14
    v_add_u32 v15, s26, v20
    v_xor_b32 v16, 32, v15
    v_xor_b32 v17, 64, v15
    v_xor_b32 v18, 96, v15
    s_setprio 2
    ds_read_b64_tr_b16 v[56:57], v36 offset:0
    ds_read_b64_tr_b16 v[58:59], v36 offset:1024
    ds_read_b64_tr_b16 v[60:61], v36 offset:2048
    ds_read_b64_tr_b16 v[62:63], v36 offset:3072
    ds_read_b64_tr_b16 v[64:65], v36 offset:4096
    ds_read_b64_tr_b16 v[66:67], v36 offset:5120
    ds_read_b64_tr_b16 v[68:69], v36 offset:6144
    ds_read_b64_tr_b16 v[70:71], v36 offset:7168
    ds_read_b64_tr_b16 v[176:177], v38 offset:0
    ds_read_b64_tr_b16 v[178:179], v38 offset:1024
    ds_read_b64_tr_b16 v[180:181], v38 offset:2048
    ds_read_b64_tr_b16 v[182:183], v38 offset:3072
    s_waitcnt vmcnt(8) lgkmcnt(10)
    v_mfma_f32_32x32x16_bf16 v[112:127], v[56:59], v[144:147], v[112:127]
    ds_read_b64_tr_b16 v[184:185], v38 offset:4096
    ds_read_b64_tr_b16 v[186:187], v38 offset:5120
    ds_read_b64_tr_b16 v[188:189], v38 offset:6144
    ds_read_b64_tr_b16 v[190:191], v38 offset:7168
    s_waitcnt vmcnt(7) lgkmcnt(12)
    v_mfma_f32_32x32x16_bf16 v[112:127], v[60:63], v[148:151], v[112:127]
    ds_read_b64_tr_b16 v[192:193], v37 offset:0
    ds_read_b64_tr_b16 v[194:195], v37 offset:1024
    ds_read_b64_tr_b16 v[196:197], v37 offset:2048
    ds_read_b64_tr_b16 v[198:199], v37 offset:3072
    s_waitcnt vmcnt(6) lgkmcnt(14)
    v_mfma_f32_32x32x16_bf16 v[112:127], v[64:67], v[152:155], v[112:127]
    ds_read_b64_tr_b16 v[200:201], v37 offset:4096
    ds_read_b64_tr_b16 v[202:203], v37 offset:5120
    ds_read_b64_tr_b16 v[204:205], v37 offset:6144
    ds_read_b64_tr_b16 v[206:207], v37 offset:7168
    s_waitcnt vmcnt(5) lgkmcnt(15)
    v_mfma_f32_32x32x16_bf16 v[112:127], v[68:71], v[156:159], v[112:127]
    ds_read_b64_tr_b16 v[208:209], v39 offset:0
    ds_read_b64_tr_b16 v[210:211], v39 offset:1024
    ds_read_b64_tr_b16 v[212:213], v39 offset:2048
    ds_read_b64_tr_b16 v[214:215], v39 offset:3072
    s_waitcnt vmcnt(4) lgkmcnt(15)
    v_mfma_f32_32x32x16_bf16 v[112:127], v[176:179], v[160:163], v[112:127]
    ds_read_b64_tr_b16 v[216:217], v39 offset:4096
    ds_read_b64_tr_b16 v[218:219], v39 offset:5120
    ds_read_b64_tr_b16 v[220:221], v39 offset:6144
    ds_read_b64_tr_b16 v[222:223], v39 offset:7168
    s_setprio 0
    s_waitcnt vmcnt(3) lgkmcnt(15)
    v_mfma_f32_32x32x16_bf16 v[112:127], v[180:183], v[164:167], v[112:127]
    s_waitcnt vmcnt(2) lgkmcnt(15)
    v_mfma_f32_32x32x16_bf16 v[112:127], v[184:187], v[168:171], v[112:127]
    s_waitcnt vmcnt(1) lgkmcnt(15)
    v_mfma_f32_32x32x16_bf16 v[112:127], v[188:191], v[172:175], v[112:127]
    s_waitcnt lgkmcnt(14)
    v_mfma_f32_32x32x16_bf16 v[128:143], v[192:195], v[144:147], v[128:143]
    s_waitcnt lgkmcnt(12)
    v_mfma_f32_32x32x16_bf16 v[128:143], v[196:199], v[148:151], v[128:143]
    s_waitcnt lgkmcnt(10)
    v_mfma_f32_32x32x16_bf16 v[128:143], v[200:203], v[152:155], v[128:143]
    s_nop 5
    ds_write_b128 v15, v[112:115] offset:0
    s_waitcnt lgkmcnt(9)
    v_mfma_f32_32x32x16_bf16 v[128:143], v[204:207], v[156:159], v[128:143]
    ds_write_b128 v16, v[116:119] offset:0
    s_waitcnt lgkmcnt(8)
    v_mfma_f32_32x32x16_bf16 v[128:143], v[208:211], v[160:163], v[128:143]
    ds_write_b128 v17, v[120:123] offset:0
    s_waitcnt lgkmcnt(7)
    v_mfma_f32_32x32x16_bf16 v[128:143], v[212:215], v[164:167], v[128:143]
    ds_write_b128 v18, v[124:127] offset:0
    s_waitcnt lgkmcnt(6)
    v_mfma_f32_32x32x16_bf16 v[128:143], v[216:219], v[168:171], v[128:143]
    s_waitcnt lgkmcnt(4)
    v_mfma_f32_32x32x16_bf16 v[128:143], v[220:223], v[172:175], v[128:143]
    v_add_u32 v32, 131072, v19
    v_xor_b32 v33, 16, v32
    v_add_u32 v34, 0, v19
    v_xor_b32 v35, 16, v34
    v_add_u32 v36, 16384, v19
    v_xor_b32 v37, 16, v36
    v_add_u32 v38, 65536, v19
    v_xor_b32 v39, 16, v38
    s_nop 3
    ds_write_b128 v15, v[128:131] offset:128
    ds_write_b128 v16, v[132:135] offset:128
    ds_write_b128 v17, v[136:139] offset:128
    ds_write_b128 v18, v[140:143] offset:128
    v_add_u32 v40, 147456, v19
    v_xor_b32 v41, 16, v40
    v_add_u32 v42, 49152, v19
    v_xor_b32 v43, 16, v42
    v_mov_b32 v30, 0xbfb8aa3b
    v_mov_b32 v31, 1.0
    s_waitcnt vmcnt(0)
    v_lshlrev_b32 v184, 16, v22
    v_and_b32 v185, 0xffff0000, v22
    v_lshlrev_b32 v186, 16, v23
    v_and_b32 v187, 0xffff0000, v23
    v_lshlrev_b32 v188, 16, v24
    v_and_b32 v189, 0xffff0000, v24
    v_lshlrev_b32 v190, 16, v25
    v_and_b32 v191, 0xffff0000, v25
    s_waitcnt lgkmcnt(0)
    s_barrier
    ds_read_b128 v[176:179], v32
    ds_read_b128 v[180:183], v33
    ds_read_b128 v[224:227], v34
    ds_read_b128 v[228:231], v35
    ds_read_b128 v[208:211], v36
    ds_read_b128 v[212:215], v37
    ds_read_b128 v[216:219], v38
    ds_read_b128 v[220:223], v39
    ds_read_b128 v[192:195], v40
    ds_read_b128 v[196:199], v41
    ds_read_b128 v[200:203], v42
    ds_read_b128 v[204:207], v43
    s_waitcnt lgkmcnt(9)
    v_pk_add_f32 v[176:177], v[176:177], v[224:225]
    v_pk_add_f32 v[178:179], v[178:179], v[226:227]
    s_waitcnt lgkmcnt(8)
    v_pk_add_f32 v[180:181], v[180:181], v[228:229]
    v_pk_add_f32 v[182:183], v[182:183], v[230:231]
    s_waitcnt lgkmcnt(5)
    v_pk_add_f32 v[208:209], v[208:209], v[216:217]
    v_pk_add_f32 v[210:211], v[210:211], v[218:219]
    s_waitcnt lgkmcnt(4)
    v_pk_add_f32 v[212:213], v[212:213], v[220:221]
    v_pk_add_f32 v[214:215], v[214:215], v[222:223]
    v_pk_add_f32 v[176:177], v[176:177], v[208:209]
    v_pk_add_f32 v[178:179], v[178:179], v[210:211]
    v_pk_add_f32 v[180:181], v[180:181], v[212:213]
    v_pk_add_f32 v[182:183], v[182:183], v[214:215]
    v_pk_mul_f32 v[208:209], v[176:177], v[30:31] op_sel_hi:[1,0]
    v_pk_mul_f32 v[210:211], v[178:179], v[30:31] op_sel_hi:[1,0]
    v_pk_mul_f32 v[212:213], v[180:181], v[30:31] op_sel_hi:[1,0]
    v_pk_mul_f32 v[214:215], v[182:183], v[30:31] op_sel_hi:[1,0]
    v_exp_f32 v208, v208
    v_exp_f32 v209, v209
    s_waitcnt lgkmcnt(1)
    v_pk_add_f32 v[192:193], v[192:193], v[200:201]
    v_exp_f32 v210, v210
    v_exp_f32 v211, v211
    v_pk_add_f32 v[194:195], v[194:195], v[202:203]
    v_exp_f32 v212, v212
    v_exp_f32 v213, v213
    s_waitcnt lgkmcnt(0)
    v_pk_add_f32 v[196:197], v[196:197], v[204:205]
    v_exp_f32 v214, v214
    v_exp_f32 v215, v215
    v_pk_add_f32 v[198:199], v[198:199], v[206:207]
    v_pk_add_f32 v[208:209], v[208:209], v[30:31] op_sel:[0,1] op_sel_hi:[1,1]
    v_pk_add_f32 v[210:211], v[210:211], v[30:31] op_sel:[0,1] op_sel_hi:[1,1]
    v_pk_add_f32 v[212:213], v[212:213], v[30:31] op_sel:[0,1] op_sel_hi:[1,1]
    v_pk_add_f32 v[214:215], v[214:215], v[30:31] op_sel:[0,1] op_sel_hi:[1,1]
    v_rcp_f32 v208, v208
    v_rcp_f32 v209, v209
    v_pk_mul_f32 v[176:177], v[176:177], v[192:193]
    v_rcp_f32 v210, v210
    v_rcp_f32 v211, v211
    v_pk_mul_f32 v[178:179], v[178:179], v[194:195]
    v_rcp_f32 v212, v212
    v_rcp_f32 v213, v213
    v_pk_mul_f32 v[180:181], v[180:181], v[196:197]
    v_rcp_f32 v214, v214
    v_rcp_f32 v215, v215
    v_pk_mul_f32 v[182:183], v[182:183], v[198:199]
    v_pk_fma_f32 v[184:185], v[208:209], v[176:177], v[184:185]
    v_pk_fma_f32 v[186:187], v[210:211], v[178:179], v[186:187]
    v_pk_fma_f32 v[188:189], v[212:213], v[180:181], v[188:189]
    v_pk_fma_f32 v[190:191], v[214:215], v[182:183], v[190:191]
    v_cvt_pk_bf16_f32 v22, v184, v185
    v_cvt_pk_bf16_f32 v23, v186, v187
    v_cvt_pk_bf16_f32 v24, v188, v189
    v_cvt_pk_bf16_f32 v25, v190, v191
    buffer_store_dwordx4 v[22:25], v21, s[64:67], 0 offen sc0 sc1
    s_endpgm
R_CFH:
    s_mov_b32 s27, 0x8000
L_CFH:
    s_sleep 16
    v_lshlrev_b32 v53, 6, v0
    buffer_load_dword v53, v53, s[60:63], 0 offen offset:0 sc1
    s_waitcnt vmcnt(0)
    v_cmp_gt_u32 vcc, v52, v53
    s_cbranch_vccz B_CFH
    s_sub_u32 s27, s27, 1
    s_cmp_lg_u32 s27, 0
    s_cbranch_scc1 L_CFH
    s_branch B_CFH
R_KP:
    s_mov_b32 s27, 0x8000
L_KP:
    s_sleep 6
    buffer_load_dwordx4 v[22:25], v18, s[56:59], s92 offen sc1
    buffer_load_dwordx4 v[48:51], v19, s[56:59], s92 offen sc1
    s_waitcnt vmcnt(0)
    v_max3_u32 v30, v22, v23, v24
    v_max3_u32 v30, v30, v25, v48
    v_max3_u32 v30, v30, v49, v50
    v_max_u32 v30, v30, v51
    v_cmp_eq_u32 vcc, -1, v30
    s_cbranch_vccz B_KP
    s_sub_u32 s27, s27, 1
    s_cmp_lg_u32 s27, 0
    s_cbranch_scc1 L_KP
    s_branch B_KP
R_P0H:
    s_mov_b32 s27, 0x8000
L_P0H:
    s_sleep 6
    buffer_load_dword v53, v52, s[56:59], 0 offen offset:0 sc1
    s_waitcnt vmcnt(0)
    v_lshrrev_b32 v53, 3, v53
    v_cmp_gt_u32 vcc, v5, v53
    s_cbranch_vccz B_P0H
    s_sub_u32 s27, s27, 1
    s_cmp_lg_u32 s27, 0
    s_cbranch_scc1 L_P0H
    s_branch B_P0H
R_KF2:
    s_mov_b32 s27, 0x8000
L_KF2:
    s_sleep 6
    buffer_load_dwordx4 v[240:243], v1, s[56:59], s96 offen offset:0 sc1
    buffer_load_dwordx4 v[244:247], v1, s[56:59], s96 offen offset:1024 sc1
    buffer_load_dwordx4 v[248:251], v1, s[56:59], s96 offen offset:2048 sc1
    buffer_load_dwordx4 v[252:255], v1, s[56:59], s96 offen offset:3072 sc1
    s_waitcnt vmcnt(0)
    v_max3_u32 v26, v240, v241, v242
    v_max3_u32 v27, v243, v244, v245
    v_max3_u32 v26, v26, v246, v247
    v_max3_u32 v27, v27, v248, v249
    v_max3_u32 v26, v26, v250, v251
    v_max3_u32 v27, v27, v252, v253
    v_max3_u32 v26, v26, v254, v255
    v_max_u32 v26, v26, v27
    v_cmp_eq_u32 vcc, -1, v26
    s_cbranch_vccz B_KF2
    s_sub_u32 s27, s27, 1
    s_cmp_lg_u32 s27, 0
    s_cbranch_scc1 L_KF2
    s_branch B_KF2
KM_NOTILE:
    s_nop 7
    s_nop 7
    v_pk_mul_f32 v[60:61], v[80:81], v[80:81]
    v_pk_mul_f32 v[62:63], v[82:83], v[82:83]
    v_pk_fma_f32 v[60:61], v[60:61], v[10:11], v[10:11] op_sel:[0,1,0] op_sel_hi:[1,1,0]
    v_pk_fma_f32 v[62:63], v[62:63], v[10:11], v[10:11] op_sel:[0,1,0] op_sel_hi:[1,1,0]
    v_pk_mul_f32 v[60:61], v[80:81], v[60:61]
    v_pk_mul_f32 v[62:63], v[82:83], v[62:63]
    v_exp_f32 v60, v60
    v_exp_f32 v61, v61
    v_pk_mul_f32 v[88:89], v[80:81], v[88:89]
    v_exp_f32 v62, v62
    v_exp_f32 v63, v63
    v_pk_mul_f32 v[90:91], v[82:83], v[90:91]
    v_pk_fma_f32 v[60:61], v[60:61], v[12:13], v[12:13] op_sel_hi:[1,0,0]
    v_pk_fma_f32 v[62:63], v[62:63], v[12:13], v[12:13] op_sel_hi:[1,0,0]
    v_rcp_f32 v60, v60
    v_rcp_f32 v61, v61
    v_rcp_f32 v62, v62
    v_rcp_f32 v63, v63
    v_pk_mul_f32 v[88:89], v[88:89], v[60:61]
    v_pk_mul_f32 v[90:91], v[90:91], v[62:63]
    v_cvt_pk_bf16_f32 v56, v88, v89
    v_cvt_pk_bf16_f32 v57, v90, v91
    v_pk_mul_f32 v[60:61], v[84:85], v[84:85]
    v_pk_mul_f32 v[62:63], v[86:87], v[86:87]
    v_pk_fma_f32 v[60:61], v[60:61], v[10:11], v[10:11] op_sel:[0,1,0] op_sel_hi:[1,1,0]
    v_pk_fma_f32 v[62:63], v[62:63], v[10:11], v[10:11] op_sel:[0,1,0] op_sel_hi:[1,1,0]
    v_pk_mul_f32 v[60:61], v[84:85], v[60:61]
    v_pk_mul_f32 v[62:63], v[86:87], v[62:63]
    v_exp_f32 v60, v60
    v_exp_f32 v61, v61
    v_pk_mul_f32 v[92:93], v[84:85], v[92:93]
    v_exp_f32 v62, v62
    v_exp_f32 v63, v63
    v_pk_mul_f32 v[94:95], v[86:87], v[94:95]
    v_pk_fma_f32 v[60:61], v[60:61], v[12:13], v[12:13] op_sel_hi:[1,0,0]
    v_pk_fma_f32 v[62:63], v[62:63], v[12:13], v[12:13] op_sel_hi:[1,0,0]
    v_rcp_f32 v60, v60
    v_rcp_f32 v61, v61
    v_rcp_f32 v62, v62
    v_rcp_f32 v63, v63
    v_pk_mul_f32 v[92:93], v[92:93], v[60:61]
    v_pk_mul_f32 v[94:95], v[94:95], v[62:63]
    v_cvt_pk_bf16_f32 v58, v92, v93
    v_cvt_pk_bf16_f32 v59, v94, v95
    buffer_store_dwordx4 v[56:59], v1, s[56:59], s99 offen sc0 sc1
    v_cvt_pk_bf16_f32 v32, v112, v113
    v_cvt_pk_bf16_f32 v33, v114, v115
    v_cvt_pk_bf16_f32 v34, v116, v117
    v_cvt_pk_bf16_f32 v35, v118, v119
    v_cvt_pk_bf16_f32 v36, v120, v121
    v_cvt_pk_bf16_f32 v37, v122, v123
    v_cvt_pk_bf16_f32 v38, v124, v125
    v_mov_b32 v39, 0
    v_cvt_pk_bf16_f32 v40, v128, v129
    v_cvt_pk_bf16_f32 v41, v130, v131
    v_cvt_pk_bf16_f32 v42, v132, v133
    v_cvt_pk_bf16_f32 v43, v134, v135
    v_cvt_pk_bf16_f32 v44, v136, v137
    v_cvt_pk_bf16_f32 v45, v138, v139
    v_cvt_pk_bf16_f32 v46, v140, v141
    v_mov_b32 v47, 0
    s_waitcnt vmcnt(0)
    s_barrier
    buffer_atomic_add v5, v52, s[56:59], 0 offen offset:512 sc1
    buffer_load_dwordx4 v[240:243], v1, s[56:59], s96 offen offset:0 sc1
    buffer_load_dwordx4 v[244:247], v1, s[56:59], s96 offen offset:1024 sc1
    buffer_load_dwordx4 v[248:251], v1, s[56:59], s96 offen offset:2048 sc1
    buffer_load_dwordx4 v[252:255], v1, s[56:59], s96 offen offset:3072 sc1
    s_waitcnt vmcnt(3)
    v_max3_u32 v26, v240, v241, v242
    s_waitcnt vmcnt(2)
    v_max3_u32 v27, v243, v244, v245
    v_max3_u32 v26, v26, v246, v247
    s_waitcnt vmcnt(1)
    v_max3_u32 v27, v27, v248, v249
    v_max3_u32 v26, v26, v250, v251
    s_waitcnt vmcnt(0)
    v_max3_u32 v27, v27, v252, v253
    v_max3_u32 v26, v26, v254, v255
    v_max_u32 v26, v26, v27
    v_cmp_eq_u32 vcc, -1, v26
    s_cbranch_vccnz R_KF2
B_KF2:
    v_mfma_f32_32x32x16_bf16 v[80:95], v[240:243], v[32:35], 0
    v_mfma_f32_32x32x16_bf16 v[96:111], v[248:251], v[40:43], 0
    v_mfma_f32_32x32x16_bf16 v[80:95], v[244:247], v[36:39], v[80:95]
    v_mfma_f32_32x32x16_bf16 v[96:111], v[252:255], v[44:47], v[96:111]
    s_nop 10
    v_rcp_f32 v26, v93
    v_rcp_f32 v27, v109
    v_mov_b32 v28, 0x358637bd
    v_fmac_f32 v28, v26, v92
    v_fmac_f32 v28, v27, v108
    v_rcp_f32 v28, v28
    s_nop 0
    v_mul_f32 v26, v26, v28
    v_mul_f32 v27, v27, v28
    v_mov_b32 v29, v26
    v_mov_b32 v30, v27
    s_nop 0
    v_permlane32_swap_b32 v29, v26
    v_permlane32_swap_b32 v30, v27
    v_pk_mul_f32 v[80:81], v[80:81], v[26:27] op_sel_hi:[1,0]
    v_pk_mul_f32 v[82:83], v[82:83], v[26:27] op_sel_hi:[1,0]
    v_pk_mul_f32 v[84:85], v[84:85], v[26:27] op_sel_hi:[1,0]
    v_pk_mul_f32 v[86:87], v[86:87], v[26:27] op_sel_hi:[1,0]
    v_pk_mul_f32 v[88:89], v[88:89], v[26:27] op_sel_hi:[1,0]
    v_pk_mul_f32 v[90:91], v[90:91], v[26:27] op_sel_hi:[1,0]
    v_pk_mul_f32 v[92:93], v[92:93], v[26:27] op_sel_hi:[1,0]
    v_pk_mul_f32 v[94:95], v[94:95], v[26:27] op_sel_hi:[1,0]
    v_pk_fma_f32 v[80:81], v[96:97], v[26:27], v[80:81] op_sel:[0,1,0] op_sel_hi:[1,1,1]
    v_pk_fma_f32 v[82:83], v[98:99], v[26:27], v[82:83] op_sel:[0,1,0] op_sel_hi:[1,1,1]
    v_pk_fma_f32 v[84:85], v[100:101], v[26:27], v[84:85] op_sel:[0,1,0] op_sel_hi:[1,1,1]
    v_pk_fma_f32 v[86:87], v[102:103], v[26:27], v[86:87] op_sel:[0,1,0] op_sel_hi:[1,1,1]
    v_pk_fma_f32 v[88:89], v[104:105], v[26:27], v[88:89] op_sel:[0,1,0] op_sel_hi:[1,1,1]
    v_pk_fma_f32 v[90:91], v[106:107], v[26:27], v[90:91] op_sel:[0,1,0] op_sel_hi:[1,1,1]
    v_pk_fma_f32 v[92:93], v[108:109], v[26:27], v[92:93] op_sel:[0,1,0] op_sel_hi:[1,1,1]
    v_pk_fma_f32 v[94:95], v[110:111], v[26:27], v[94:95] op_sel:[0,1,0] op_sel_hi:[1,1,1]
    v_cvt_pk_bf16_f32 v32, v80, v81
    v_cvt_pk_bf16_f32 v33, v82, v83
    v_cvt_pk_bf16_f32 v34, v84, v85
    v_cvt_pk_bf16_f32 v35, v86, v87
    v_cvt_pk_bf16_f32 v36, v88, v89
    v_cvt_pk_bf16_f32 v37, v90, v91
    v_cvt_pk_bf16_f32 v38, v92, v93
    v_cvt_pk_bf16_f32 v39, v94, v95
    v_cndmask_b32 v38, v38, 0, s[100:101]
    v_cndmask_b32 v39, v39, 0, s[100:101]
    buffer_store_dwordx4 v[32:35], v1, s[56:59], s90 offen sc0 sc1
    buffer_store_dwordx4 v[36:39], v1, s[56:59], s90 offen offset:1024 sc0 sc1
    s_waitcnt vmcnt(0)
    s_barrier
    buffer_atomic_add v5, v52, s[56:59], 0 offen offset:384 sc1
    s_endpgm
R_KF:
    s_mov_b32 s27, 0x8000
L_KF:
    s_sleep 6
    buffer_load_dwordx4 v[240:243], v1, s[56:59], s96 offen offset:0 sc1
    buffer_load_dwordx4 v[244:247], v1, s[56:59], s96 offen offset:1024 sc1
    buffer_load_dwordx4 v[248:251], v1, s[56:59], s96 offen offset:2048 sc1
    buffer_load_dwordx4 v[252:255], v1, s[56:59], s96 offen offset:3072 sc1
    s_waitcnt vmcnt(0)
    v_max3_u32 v26, v240, v241, v242
    v_max3_u32 v27, v243, v244, v245
    v_max3_u32 v26, v26, v246, v247
    v_max3_u32 v27, v27, v248, v249
    v_max3_u32 v26, v26, v250, v251
    v_max3_u32 v27, v27, v252, v253
    v_max3_u32 v26, v26, v254, v255
    v_max_u32 v26, v26, v27
    v_cmp_eq_u32 vcc, -1, v26
    s_cbranch_vccz B_KF
    s_sub_u32 s27, s27, 1
    s_cmp_lg_u32 s27, 0
    s_cbranch_scc1 L_KF
    s_branch B_KF
R_P1H:
    s_mov_b32 s27, 0x8000
L_P1H:
    s_sleep 6
    buffer_load_dword v53, v52, s[56:59], 0 offen offset:128 sc1
    s_waitcnt vmcnt(0)
    v_lshrrev_b32 v53, 3, v53
    v_cmp_gt_u32 vcc, v5, v53
    s_cbranch_vccz B_P1H
    s_sub_u32 s27, s27, 1
    s_cmp_lg_u32 s27, 0
    s_cbranch_scc1 L_P1H
    s_branch B_P1H
R_P4H:
    s_mov_b32 s27, 0x8000
L_P4H:
    s_sleep 6
    buffer_load_dword v53, v52, s[56:59], 0 offen offset:512 sc1
    s_waitcnt vmcnt(0)
    v_lshrrev_b32 v53, 3, v53
    v_cmp_gt_u32 vcc, v5, v53
    s_cbranch_vccz B_P4H
    s_sub_u32 s27, s27, 1
    s_cmp_lg_u32 s27, 0
    s_cbranch_scc1 L_P4H
    s_branch B_P4H
R_P3H:
    s_mov_b32 s27, 0x8000
L_P3H:
    s_sleep 6
    buffer_load_dword v53, v52, s[56:59], 0 offen offset:384 sc1
    s_waitcnt vmcnt(0)
    v_lshrrev_b32 v53, 3, v53
    v_cmp_gt_u32 vcc, v5, v53
    s_cbranch_vccz B_P3H
    s_sub_u32 s27, s27, 1
    s_cmp_lg_u32 s27, 0
    s_cbranch_scc1 L_P3H
    s_branch B_P3H
R_P2H:
    s_mov_b32 s27, 0x8000
L_P2H:
    s_sleep 6
    buffer_load_dword v53, v2, s[56:59], 0 offen offset:256 sc1
    s_waitcnt vmcnt(0)
    v_lshrrev_b32 v53, 3, v53
    v_cmp_gt_u32 vcc, v3, v53
    s_cbranch_vccz B_P2H
    s_sub_u32 s27, s27, 1
    s_cmp_lg_u32 s27, 0
    s_cbranch_scc1 L_P2H
    s_branch B_P2H
KM_EXIT:
    s_endpgm
.section .rodata,"a"
.p2align 6
.amdhsa_kernel recurrent_scan__linear_kernel_hedgehog__glu_gated_geglu__prompt_kernel
  .amdhsa_next_free_vgpr 256
  .amdhsa_next_free_sgpr 102
  .amdhsa_accum_offset 256
  .amdhsa_group_segment_fixed_size 0
  .amdhsa_kernarg_size 88
  .amdhsa_user_sgpr_count 2
  .amdhsa_user_sgpr_kernarg_segment_ptr 1
  .amdhsa_system_sgpr_workgroup_id_x 1
.end_amdhsa_kernel
.text
```
